```python
import torch

def _softmax(x, axis=-1):
    return torch.softmax(x, dim=axis)
def _gelu(x):
    return torch.nn.functional.gelu(x, approximate="tanh")
def _silu(x):
    return torch.nn.functional.silu(x)
def _sigmoid(x):
    return torch.sigmoid(x)
def _layernorm(x, axis=-1, eps=1e-5):
    m = x.mean(dim=axis, keepdim=True)
    v = x.var(dim=axis, keepdim=True, unbiased=False)
    return (x - m) / torch.sqrt(v + eps)
def _scatter_add(tgt, idx, src, axis=0):
    return tgt.clone().index_add_(axis, idx, src)
def _segment_sum(src, seg, n):
    out = torch.zeros((n,) + src.shape[1:], dtype=src.dtype)
    return out.index_add_(0, seg, src)
def _pad(x, pw):
    flat = tuple(v for pair in reversed(pw) for v in pair)
    return torch.nn.functional.pad(x, flat)

kernel_name = 'gated_mix__ssm_conv_s5__mixer_channel_mlp__prompt'

def setup_inputs():

    _w = (lambda a: (lambda t: t.to(torch.bfloat16) if t.is_floating_point() else t)(torch.as_tensor(a)))
    def _A_setup():
        B, S, D = 1, 2048, 448
        P = D
        Lambda_re = -0.5 * (lambda _x: torch.exp(torch.as_tensor(_x)))((lambda *s: torch.randn(*s, dtype=torch.bfloat16) * 0.4)(P))
        Lambda_im = (lambda *s: torch.randn(*s, dtype=torch.bfloat16) * 0.8)(P) * 1.0
        B_re = (lambda *s: torch.randn(*s, dtype=torch.bfloat16) * 0.8)(P, D) * (D ** -0.5)
        B_im = (lambda *s: torch.randn(*s, dtype=torch.bfloat16) * 0.8)(P, D) * (D ** -0.5)
        C_re = (lambda *s: torch.randn(*s, dtype=torch.bfloat16) * 0.8)(D, P) * (P ** -0.5)
        C_im = (lambda *s: torch.randn(*s, dtype=torch.bfloat16) * 0.8)(D, P) * (P ** -0.5)
        log_dt = (lambda *s: torch.randn(*s, dtype=torch.bfloat16) * 0.4)(P) * 0.3 - 2.0
        Dskip = (lambda *s: torch.randn(*s, dtype=torch.bfloat16) * 0.1)(D)
        return {
            "x": _w((lambda *s: torch.randn(*s, dtype=torch.bfloat16) * 0.05)(B, S, D)),
            "Lambda_re": _w(Lambda_re),
            "Lambda_im": _w(Lambda_im),
            "B_re": _w(B_re),
            "B_im": _w(B_im),
            "C_re": _w(C_re),
            "C_im": _w(C_im),
            "log_dt": _w(log_dt),
            "Dskip": _w(Dskip),
        }
    _A_in = _A_setup()

    def _B_setup():
        B, S, D, F = 1, 2048, 448, 1792
        return {
            "x": _w((lambda *s: torch.randn(*s, dtype=torch.bfloat16) * 0.05)(B, S, D)),
            "w1": _w((lambda *s: torch.randn(*s, dtype=torch.bfloat16) * 0.8)(D, F) * (D ** -0.5)),
            "b1": _w((lambda *s: torch.randn(*s, dtype=torch.bfloat16) * 0.4)(F)),
            "w2": _w((lambda *s: torch.randn(*s, dtype=torch.bfloat16) * 0.05)(F, D) * (F ** -0.5)),
            "b2": _w((lambda *s: torch.randn(*s, dtype=torch.bfloat16) * 0.05)(D)),
        }
    _B_in = _B_setup()

    return {
        "A_x": _A_in["x"],
        "A_Lambda_re": _A_in["Lambda_re"],
        "A_Lambda_im": _A_in["Lambda_im"],
        "A_B_re": _A_in["B_re"],
        "A_B_im": _A_in["B_im"],
        "A_C_re": _A_in["C_re"],
        "A_C_im": _A_in["C_im"],
        "A_log_dt": _A_in["log_dt"],
        "A_Dskip": _A_in["Dskip"],
        "B_x": _B_in["x"],
        "B_w1": _B_in["w1"],
        "B_b1": _B_in["b1"],
        "B_w2": _B_in["w2"],
        "B_b2": _B_in["b2"],
        "gate_w": _w((lambda *s: torch.randn(*s, dtype=torch.bfloat16) * 0.05)(448) * 16.0),
    }

def reference(A_x, A_Lambda_re, A_Lambda_im, A_B_re, A_B_im, A_C_re, A_C_im, A_log_dt, A_Dskip, B_x, B_w1, B_b1, B_w2, B_b2, gate_w):
    def _A_ref(x, Lambda_re, Lambda_im, B_re, B_im, C_re, C_im, log_dt, Dskip):
        Bsz, L, H = x.shape
        Lam = Lambda_re + 1j * Lambda_im
        Bmat = B_re + 1j * B_im
        Cmat = C_re + 1j * C_im
        dt = torch.exp(log_dt)
        Lam_bar = torch.exp(dt * Lam)
        B_bar = ((Lam_bar - 1.0) / Lam)[:, None] * Bmat
        Bu = torch.einsum("bld,pd->blp", x + 0j, B_bar)
        h = torch.zeros_like(Bu[:, 0, :])
        hs = []
        for t in range(L):
            h = Lam_bar[None, :] * h + Bu[:, t, :]
            hs.append(h)
        hseq = torch.stack(hs, 1)
        y = 2.0 * torch.einsum("blp,dp->bld", hseq, Cmat).real + x * Dskip[None, None, :]
        return y

    def _B_ref(x, w1, b1, w2, b2):
        y = _layernorm(x, axis=-1)
        h = _gelu(torch.einsum("bsd,df->bsf", y, w1) + b1)
        return torch.einsum("bsf,fd->bsd", h, w2) + b2

    x = A_x
    g = _sigmoid((x * gate_w).sum(-1, keepdims=True))
    a = _A_ref(x, A_Lambda_re, A_Lambda_im, A_B_re, A_B_im, A_C_re, A_C_im, A_log_dt, A_Dskip)
    b = _B_ref(x, B_w1, B_b1, B_w2, B_b2)
    return g * a + (1 - g) * b
```

```asm
; @launch grid=(256,1,1) block=(256,1,1) lds=163840
.amdgcn_target "amdgcn-amd-amdhsa--gfx950"
.text
.globl gated_mix__ssm_conv_s5__mixer_channel_mlp__prompt_kernel
.p2align 8
.type gated_mix__ssm_conv_s5__mixer_channel_mlp__prompt_kernel,@function
gated_mix__ssm_conv_s5__mixer_channel_mlp__prompt_kernel:
  s_cmp_ge_u32 s2, 256
  s_cbranch_scc1 L_end
  s_load_dwordx16 s[4:19], s[0:1], 0
  s_load_dwordx16 s[52:67], s[0:1], 64
  s_and_b32 s84, s2, 7
  s_bfe_u32 s80, s2, 0x20003
  s_lshl2_add_u32 s80, s84, s80
  s_lshr_b32 s84, s2, 5
  s_sub_u32 s81, 7, s84
  v_readfirstlane_b32 s82, v0
  v_and_b32 v0, 63, v0
  v_lshrrev_b32 v80, 3, v0
  v_and_b32 v81, 7, v0
  s_nop 0
  s_lshr_b32 s82, s82, 6
  s_lshl_b32 s83, s82, 12
  s_lshr_b32 s91, s82, 1
  s_and_b32 s88, s82, 1
  s_lshr_b32 s84, s80, 2
  s_mul_i32 s85, s81, 1
  s_add_u32 s84, s84, s85
  s_mul_i32 s85, s84, 37
  s_lshr_b32 s85, s85, 8
  s_mul_i32 s85, s85, 7
  s_sub_u32 s84, s84, s85
  s_lshl_b32 s20, s84, 7
  s_lshl_b32 s84, s91, 5
  s_lshl3_add_u32 s84, s88, s84
  v_lshrrev_b32 v72, 2, v80
  v_lshlrev_b32 v72, 4, v72
  v_and_b32 v73, 3, v80
  v_add3_u32 v87, v72, v73, s84
  v_mul_u32_u24 v72, 896, v87
  s_cmp_eq_u32 s81, 7
  s_cbranch_scc1 L_helper
  v_lshrrev_b32 v73, 1, v80
  v_xor_b32 v73, v73, v81
  v_lshlrev_b32 v88, 4, v73
  v_add_u32 v66, v72, v88
  v_xor_b32 v73, 64, v88
  v_add_u32 v73, 2560, v73
  v_add_u32 v67, v72, v73
  v_mul_u32_u24 v89, 896, v80
  v_and_b32 v73, 6, v80
  v_xor_b32 v73, v73, v81
  v_lshl_add_u32 v68, v73, 4, v89
  v_add_u32 v69, 6144, v68
  v_xor_b32 v70, 16, v68
  v_xor_b32 v71, 16, v69
  s_lshl2_add_u32 s90, s81, s82
  s_mul_i32 s87, s90, 14336
  s_mul_i32 s84, s80, 57344
  s_sub_u32 s85, s87, 2048
  s_mov_b32 s42, 57344
  s_mov_b32 s43, 0x00020000
  s_mov_b32 s46, 16384
  s_mov_b32 s47, 0x00020000
  s_mov_b64 s[50:51], s[46:47]
  s_ashr_i32 s89, s85, 31
  s_lshr_b32 m0, s83, 1
  s_waitcnt lgkmcnt(0)
  s_add_u32 s40, s4, s84
  s_addc_u32 s41, s5, 0
  buffer_load_dwordx4 v66, s[40:43], s20 offen offset:0 lds
  buffer_load_dwordx4 v67, s[40:43], s20 offen offset:1024 lds
  s_load_dwordx4 s[72:75], s[0:1], 128
  v_and_b32 v82, 31, v0
  v_lshrrev_b32 v83, 5, v0
  s_lshl_b32 s90, s90, 5
  v_and_b32 v73, 30, v82
  v_add_u32 v90, s90, v73
  global_load_ushort v92, v90, s[6:7]
  global_load_ushort v93, v90, s[8:9]
  global_load_ushort v94, v90, s[18:19]
  s_add_u32 s44, s10, s87
  s_addc_u32 s45, s11, 0
  s_add_u32 s48, s12, s85
  s_addc_u32 s49, s13, s89
  s_add_u32 m0, s83, 65536
  s_nop 0
  buffer_load_dwordx4 v68, s[44:47], s20 offen offset:0 lds
  buffer_load_dwordx4 v69, s[44:47], s20 offen offset:1024 lds
  buffer_load_dwordx4 v70, s[48:51], s20 offen offset:2048 lds
  buffer_load_dwordx4 v71, s[48:51], s20 offen offset:3072 lds
  s_lshl1_add_u32 s84, s81, s88
  s_lshl_b32 s84, s84, 5
  v_add_lshl_u32 v91, v82, s84, 1
  global_load_ushort v95, v91, s[52:53]
  global_load_ushort v79, v91, s[62:63]
  s_add_u32 s21, s20, 128
  s_cmp_eq_u32 s21, 896
  s_cselect_b32 s21, 0, s21
  s_add_u32 s22, s21, 128
  s_cmp_eq_u32 s22, 896
  s_cselect_b32 s22, 0, s22
  s_lshr_b32 m0, s83, 1
  s_add_u32 m0, m0, 8192
  s_nop 0
  buffer_load_dwordx4 v66, s[40:43], s21 offen offset:0 lds
  buffer_load_dwordx4 v67, s[40:43], s21 offen offset:1024 lds
L_pf:
  s_getpc_b64 s[100:101]
  s_and_b32 s86, s80, 3
  s_lshl2_add_u32 s86, s81, s86
  s_lshl2_add_u32 s86, s86, s82
  s_mul_i32 s86, s86, 2
  v_min_u32 v2, 1, v0
  v_add_lshl_u32 v2, v2, s86, 7
  v_min_u32 v2, 0x44c4, v2
  global_load_dword v1, v2, s[100:101]
  s_add_u32 s23, s22, 128
  s_cmp_eq_u32 s23, 896
  s_cselect_b32 s23, 0, s23
  s_add_u32 s24, s23, 128
  s_cmp_eq_u32 s24, 896
  s_cselect_b32 s24, 0, s24
  s_add_u32 s25, s24, 128
  s_cmp_eq_u32 s25, 896
  s_cselect_b32 s25, 0, s25
  s_add_u32 s26, s25, 128
  s_cmp_eq_u32 s26, 896
  s_cselect_b32 s26, 0, s26
  s_mul_i32 s84, s80, 37
  s_bfe_u32 s90, s84, 0x10008
  s_lshl1_add_u32 s84, s81, s90
  s_lshl_b32 s84, s84, 8
  s_add_u32 s52, s56, s84
  s_addc_u32 s53, s57, 0
  s_mov_b32 s54, 1602304
  s_mov_b32 s55, 0x00020000
  s_mul_i32 s27, s20, 1792
  s_mul_i32 s28, s21, 1792
  s_mul_i32 s29, s22, 1792
  s_mul_i32 s30, s23, 1792
  s_mul_i32 s31, s24, 1792
  s_mul_i32 s32, s25, 1792
  s_mul_i32 s33, s26, 1792
  v_and_b32 v72, 2, v80
  v_lshlrev_b32 v72, 1, v72
  v_xor_b32 v72, v72, v81
  v_lshlrev_b32 v72, 4, v72
  s_mul_i32 s84, s88, 57344
  v_add3_u32 v8, v72, v89, s84
  s_mul_i32 s84, s88, 114688
  s_lshl_b32 s85, s91, 7
  s_add_u32 s84, s84, s85
  v_lshl_add_u32 v72, v89, 2, v72
  v_add_u32 v4, s84, v72
  v_add_u32 v12, v88, v89
  v_add_u32 v5, 27648, v4
  v_add_u32 v9, 6144, v8
  v_add_u32 v13, 6144, v12
  v_xor_b32 v13, 64, v13
  v_add_u32 v6, 55296, v4
  v_add_u32 v10, 26624, v8
  v_add_u32 v14, 12288, v12
  v_add_u32 v7, 82944, v4
  v_add_u32 v11, 32768, v8
  v_add_u32 v15, 18432, v12
  v_xor_b32 v15, 64, v15
  v_bfe_u32 v84, v0, 2, 2
  v_bfe_u32 v85, v0, 4, 1
  v_and_b32 v86, 3, v0
  v_bfe_u32 v72, v82, 1, 3
  v_xor_b32 v72, v72, v83
  v_lshlrev_b32 v72, 4, v72
  v_lshl_add_u32 v16, v82, 7, v72
  v_and_b32 v72, 1, v82
  v_bfe_u32 v73, v82, 2, 2
  v_lshl_add_u32 v73, v73, 1, v72
  v_xor_b32 v73, v73, v83
  v_lshlrev_b32 v73, 4, v73
  v_lshl_add_u32 v73, v72, 11, v73
  v_lshrrev_b32 v74, 1, v82
  v_lshl_add_u32 v73, v74, 7, v73
  s_add_u32 s84, s83, 65536
  v_add_u32 v20, s84, v73
  v_xor_b32 v17, 32, v16
  v_xor_b32 v21, 32, v20
  v_xor_b32 v18, 64, v16
  v_xor_b32 v22, 64, v20
  v_xor_b32 v19, 96, v16
  v_xor_b32 v23, 96, v20
  v_add_u32 v24, 0x10000, v20
  v_add_u32 v25, 0x10000, v21
  v_add_u32 v26, 0x10000, v22
  v_add_u32 v27, 0x10000, v23
  s_mul_i32 s84, s81, 229376
  s_add_u32 s56, s60, s84
  s_addc_u32 s57, s61, 0
  s_mov_b32 s58, 229376
  s_mov_b32 s59, 0x00020000
  s_mul_i32 s84, s80, 114688
  s_add_u32 s76, s66, s84
  s_addc_u32 s77, s67, 0
  s_mov_b32 s78, 114688
  s_mov_b32 s79, 0x00020000
  s_lshl_b32 s84, s81, 7
  s_add_u32 s60, s14, s84
  s_addc_u32 s61, s15, 0
  s_mov_b32 s62, 400640
  s_mov_b32 s63, 0x00020000
  s_add_u32 s64, s16, s84
  s_addc_u32 s65, s17, 0
  s_mov_b32 s66, 400640
  s_mov_b32 s67, 0x00020000
  s_waitcnt lgkmcnt(0)
  s_mov_b64 s[16:17], s[72:73]
  s_mov_b64 s[68:69], s[74:75]
  s_mov_b32 s70, 268435456
  s_mov_b32 s71, 0x00020000
  s_lshl_b32 s84, s81, 15
  s_add_u32 s72, s68, s84
  s_addc_u32 s73, s69, 0
  s_mov_b32 s74, 32768
  s_mov_b32 s75, 0x00020000
  s_mul_i32 s84, s80, 43
  s_lshr_b32 s84, s84, 8
  s_mul_i32 s84, s84, 6
  s_sub_u32 s84, s80, s84
  s_mov_b32 s12, s84
  s_add_u32 s84, s84, s91
  s_mul_i32 s89, s90, 114688
  s_cmp_ge_u32 s84, 6
  s_cselect_b32 s85, 6, 0
  s_sub_u32 s84, s84, s85
  s_add_u32 s85, s84, s81
  s_add_u32 s85, s85, 1
  s_cmp_ge_u32 s85, 7
  s_cselect_b32 s87, 7, 0
  s_sub_u32 s85, s85, s87
  s_lshl_b32 s87, s85, 7
  s_add_u32 s34, s87, s89
  s_sub_u32 s87, s87, s89
  s_add_u32 s35, s87, 114688
  s_lshl1_add_u32 s87, s85, s88
  s_mul_i32 s4, s87, 28672
  s_add_u32 s84, s84, 2
  s_cmp_ge_u32 s84, 6
  s_cselect_b32 s85, 6, 0
  s_sub_u32 s84, s84, s85
  s_add_u32 s85, s84, s81
  s_add_u32 s85, s85, 1
  s_cmp_ge_u32 s85, 7
  s_cselect_b32 s87, 7, 0
  s_sub_u32 s85, s85, s87
  s_lshl_b32 s87, s85, 7
  s_add_u32 s36, s87, s89
  s_sub_u32 s87, s87, s89
  s_add_u32 s37, s87, 114688
  s_lshl1_add_u32 s87, s85, s88
  s_mul_i32 s5, s87, 28672
  s_add_u32 s84, s84, 2
  s_cmp_ge_u32 s84, 6
  s_cselect_b32 s85, 6, 0
  s_sub_u32 s84, s84, s85
  s_add_u32 s85, s84, s81
  s_add_u32 s85, s85, 1
  s_cmp_ge_u32 s85, 7
  s_cselect_b32 s87, 7, 0
  s_sub_u32 s85, s85, s87
  s_lshl_b32 s87, s85, 7
  s_add_u32 s38, s87, s89
  s_sub_u32 s87, s87, s89
  s_add_u32 s39, s87, 114688
  s_lshl1_add_u32 s87, s85, s88
  s_mul_i32 s6, s87, 28672
  s_add_u32 s84, s84, 2
  s_lshl1_add_u32 s84, s81, s88
  s_mul_i32 s7, s84, 28672
  s_mul_i32 s84, s91, 14336
  s_lshl_b32 s85, s81, 7
  s_add_u32 s84, s84, s85
  s_add_u32 s8, s84, s89
  s_sub_u32 s84, s84, s89
  s_add_u32 s9, s84, 114688
  s_lshl1_add_u32 s84, s81, s90
  s_lshl2_add_u32 s84, s84, s82
  s_lshl_b32 s84, s84, 9
  s_add_u32 s14, s84, 393216
  s_xor_b32 s15, s14, 2048
  s_lshl_b32 s89, s80, 12
  s_add_u32 s89, s89, 262144
  s_lshr_b32 s84, s20, 7
  s_sub_u32 s84, s81, s84
  s_cselect_b32 s85, 7, 0
  s_add_u32 s84, s84, s85
  s_lshl1_add_u32 s84, s84, s91
  s_lshl_b32 s84, s84, 12
  s_lshl_b32 s85, s88, 6
  v_xor_b32 v73, s85, v16
  v_add_u32 v76, s84, v73
  v_xor_b32 v77, 32, v76
  v_lshrrev_b32 v73, 1, v84
  v_xor_b32 v74, s88, v73
  v_lshlrev_b32 v74, 6, v74
  v_lshl_add_u32 v74, v84, 7, v74
  v_lshl_add_u32 v74, v85, 5, v74
  v_lshl_add_u32 v74, v86, 3, v74
  v_lshl_add_u32 v74, v83, 9, v74
  v_add_u32 v36, 0, v74
  v_add_u32 v37, 65536, v74
  s_lshl_b32 s84, s91, 13
  v_add_u32 v32, s84, v74
  v_lshl_add_u32 v28, v83, 9, v32
  v_add_u32 v29, 65536, v28
  v_add_u32 v33, 65536, v32
  v_add_u32 v30, 131072, v28
  v_add_u32 v34, 131072, v32
  v_lshlrev_b32 v74, 4, v0
  s_lshl_b32 s85, s82, 11
  v_add_u32 v35, s85, v74
  v_add_u32 v38, s84, v74
  v_xor_b32 v39, 0x2000, v38
  v_mov_b32 v42, v74
  v_bfe_u32 v74, v82, 2, 1
  v_xor_b32 v74, v74, v83
  v_lshl_add_u32 v74, v74, 1, v72
  v_lshlrev_b32 v74, 4, v74
  v_lshl_add_u32 v74, v72, 12, v74
  v_lshrrev_b32 v75, 1, v82
  v_lshl_add_u32 v74, v75, 6, v74
  s_lshl_b32 s85, s82, 10
  s_add_u32 s85, s85, 16384
  v_add_u32 v40, s85, v74
  v_xor_b32 v41, 16, v40
  v_and_b32 v74, 1, v86
  v_xor_b32 v74, v74, v73
  v_lshl_add_u32 v74, v74, 1, v85
  v_lshlrev_b32 v74, 4, v74
  v_lshrrev_b32 v75, 1, v86
  v_lshl_add_u32 v74, v75, 3, v74
  v_lshl_add_u32 v75, v83, 3, v84
  v_lshl_add_u32 v74, v75, 6, v74
  s_add_u32 s84, s84, 16384
  v_add_u32 v44, s84, v74
  v_xor_b32 v45, 0x2000, v44
  v_xor_b32 v46, 0x1010, v44
  v_xor_b32 v47, 0x3010, v44
  s_mul_i32 s84, s91, 57344
  s_lshl_b32 s85, s88, 7
  s_add_u32 s84, s84, s85
  s_lshl_b32 s87, s81, 8
  s_add_u32 s84, s84, s87
  v_mul_u32_u24 v74, 28672, v83
  v_lshl_add_u32 v74, v82, 2, v74
  v_add_u32 v48, s84, v74
  s_add_u32 m0, s83, 81920
  s_nop 0
  buffer_load_dwordx4 v68, s[44:47], s21 offen offset:0 lds
  buffer_load_dwordx4 v69, s[44:47], s21 offen offset:1024 lds
  buffer_load_dwordx4 v70, s[48:51], s21 offen offset:2048 lds
  buffer_load_dwordx4 v71, s[48:51], s21 offen offset:3072 lds
  s_lshr_b32 m0, s83, 1
  s_add_u32 m0, m0, 16384
  s_nop 0
  buffer_load_dwordx4 v66, s[40:43], s22 offen offset:0 lds
  buffer_load_dwordx4 v67, s[40:43], s22 offen offset:1024 lds
  s_add_u32 m0, s83, 98304
  s_nop 0
  buffer_load_dwordx4 v68, s[44:47], s22 offen offset:0 lds
  buffer_load_dwordx4 v69, s[44:47], s22 offen offset:1024 lds
  buffer_load_dwordx4 v70, s[48:51], s22 offen offset:2048 lds
  buffer_load_dwordx4 v71, s[48:51], s22 offen offset:3072 lds
  s_waitcnt vmcnt(15)
  s_barrier
  s_lshr_b32 m0, s83, 1
  s_add_u32 m0, m0, 24576
  ds_read_b128 a[0:3], v16 offset:0
  ds_read_b128 a[4:7], v16 offset:4096
  ds_read_b128 v[96:99], v20 offset:0
  ds_read_b128 a[8:11], v17 offset:0
  ds_read_b128 a[12:15], v17 offset:4096
  ds_read_b128 v[100:103], v21 offset:0
  ds_read_b128 a[16:19], v18 offset:0
  ds_read_b128 a[20:23], v18 offset:4096
  ds_read_b128 v[104:107], v22 offset:0
  ds_read_b128 a[24:27], v19 offset:0
  ds_read_b128 a[28:31], v19 offset:4096
  ds_read_b128 v[108:111], v23 offset:0
  buffer_load_dwordx4 v66, s[40:43], s23 offen offset:0 lds
  buffer_load_dwordx4 v67, s[40:43], s23 offen offset:1024 lds
  s_add_u32 m0, s83, 114688
  s_nop 0
  buffer_load_dwordx4 v68, s[44:47], s23 offen offset:0 lds
  buffer_load_dwordx4 v69, s[44:47], s23 offen offset:1024 lds
  buffer_load_dwordx4 v70, s[48:51], s23 offen offset:2048 lds
  buffer_load_dwordx4 v71, s[48:51], s23 offen offset:3072 lds
  v_lshl_add_u32 v74, v81, 4, s85
  v_lshl_add_u32 v43, v89, 1, v74
  v_add_u32 v50, 14336, v43
  v_lshlrev_b32 v31, 4, v82
  s_sub_u32 s84, 31, s80
  s_lshl2_add_u32 s84, s84, s82
  s_lshl_b32 s84, s84, 8
  v_lshrrev_b32 v74, 1, v82
  v_lshl_add_u32 v74, v74, 4, s84
  v_lshl_add_u32 v75, v83, 1, v72
  v_mov_b32 v52, 0x80000000
  v_cmp_eq_u32 vcc, 2, v75
  s_nop 1
  v_cndmask_b32 v52, v52, v74, vcc
  v_lshl_add_u32 v74, v75, 13, v74
  v_add_u32 v51, 1024, v74
  v_lshlrev_b32 v75, 3, v75
  v_sub_u32 v74, s80, v75
  v_med3_i32 v53, v74, 0, 8
  s_mov_b32 s18, 0xaaaaaaaa
  s_mov_b32 s19, 0xaaaaaaaa
  v_bfe_u32 v74, v82, 2, 1
  v_cmp_eq_u32 vcc, v74, v83
  v_lshlrev_b32 v88, 4, v72
  v_mov_b32 v74, 0x3f80
  v_lshlrev_b32 v74, v88, v74
  v_cndmask_b32 v74, 0, v74, vcc
  v_lshrrev_b32 v75, 3, v82
  v_bfe_u32 v73, v82, 1, 1
  v_lshl_add_u32 v75, v75, 1, v73
  v_cmp_eq_u32 vcc, 0, v75
  s_nop 1
  v_cndmask_b32 v73, 0, v74, vcc
  v_accvgpr_write_b32 a224, v73
  v_cmp_eq_u32 vcc, 1, v75
  s_nop 1
  v_cndmask_b32 v73, 0, v74, vcc
  v_accvgpr_write_b32 a225, v73
  v_cmp_eq_u32 vcc, 2, v75
  s_nop 1
  v_cndmask_b32 v73, 0, v74, vcc
  v_accvgpr_write_b32 a226, v73
  v_cmp_eq_u32 vcc, 3, v75
  s_nop 1
  v_cndmask_b32 v73, 0, v74, vcc
  s_waitcnt lgkmcnt(0)
  v_mfma_f32_32x32x16_bf16 v[128:143], a[0:3], v[96:99], 0
  s_waitcnt vmcnt(12)
  s_barrier
  s_lshr_b32 m0, s83, 1
  s_add_u32 m0, m0, 32768
  ds_read_b128 a[32:35], v16 offset:8192
  ds_read_b128 a[36:39], v16 offset:12288
  v_accvgpr_write_b32 a227, v73
  v_cmp_eq_u32 vcc, 4, v75
  s_nop 1
  v_cndmask_b32 v73, 0, v74, vcc
  v_accvgpr_write_b32 a228, v73
  v_mfma_f32_32x32x16_bf16 v[144:159], a[4:7], v[96:99], 0
  ds_read_b128 v[112:115], v20 offset:16384
  ds_read_b128 a[40:43], v17 offset:8192
  buffer_load_dwordx4 v66, s[40:43], s24 offen offset:0 lds
  v_cmp_eq_u32 vcc, 5, v75
  s_nop 1
  v_cndmask_b32 v73, 0, v74, vcc
  v_accvgpr_write_b32 a229, v73
  v_cmp_eq_u32 vcc, 6, v75
  s_nop 1
  v_cndmask_b32 v73, 0, v74, vcc
  v_mfma_f32_32x32x16_bf16 v[128:143], a[8:11], v[100:103], v[128:143]
  ds_read_b128 a[44:47], v17 offset:12288
  ds_read_b128 v[116:119], v21 offset:16384
  buffer_load_dwordx4 v67, s[40:43], s24 offen offset:1024 lds
  v_accvgpr_write_b32 a230, v73
  v_cmp_eq_u32 vcc, 7, v75
  s_nop 1
  v_cndmask_b32 v73, 0, v74, vcc
  v_mfma_f32_32x32x16_bf16 v[144:159], a[12:15], v[100:103], v[144:159]
  ds_read_b128 a[48:51], v18 offset:8192
  ds_read_b128 a[52:55], v18 offset:12288
  s_add_u32 m0, s83, 131072
  v_accvgpr_write_b32 a231, v73
  v_accvgpr_write_b32 a241, 0
  v_accvgpr_write_b32 a242, 0
  v_mfma_f32_32x32x16_bf16 v[128:143], a[16:19], v[104:107], v[128:143]
  ds_read_b128 v[120:123], v22 offset:16384
  ds_read_b128 a[56:59], v19 offset:8192
  buffer_load_dwordx4 v68, s[44:47], s24 offen offset:0 lds
  v_accvgpr_write_b32 a243, 0
  v_mov_b32 v231, 0
  v_lshlrev_b32 v92, 16, v92
  v_lshlrev_b32 v93, 16, v93
  v_lshlrev_b32 v94, 16, v94
  v_mfma_f32_32x32x16_bf16 v[144:159], a[20:23], v[104:107], v[144:159]
  ds_read_b128 a[60:63], v19 offset:12288
  ds_read_b128 v[124:127], v23 offset:16384
  buffer_load_dwordx4 v69, s[44:47], s24 offen offset:1024 lds
  v_mul_f32 v94, 0x3fb8aa3b, v94
  v_exp_f32 v94, v94
  s_nop 0
  v_cvt_pk_bf16_f32 v94, v94, v94
  v_mfma_f32_32x32x16_bf16 v[128:143], a[24:27], v[108:111], v[128:143]
  buffer_load_dwordx4 v70, s[48:51], s24 offen offset:2048 lds
  global_load_dword v230, v231, s[16:17] sc1
  v_lshlrev_b32 v94, 16, v94
  v_mul_f32 v74, v94, v92
  v_mul_f32 v73, v94, v93
  v_mul_f32 v74, 0x3fb8aa3b, v74
  v_mfma_f32_32x32x16_bf16 v[144:159], a[28:31], v[108:111], v[144:159]
  buffer_load_dwordx4 v71, s[48:51], s24 offen offset:3072 lds
  v_exp_f32 v94, v74
  v_mul_f32 v73, 0x3e22f983, v73
  s_waitcnt lgkmcnt(0)
  v_mfma_f32_32x32x16_bf16 v[128:143], a[32:35], v[112:115], v[128:143]
  s_waitcnt vmcnt(13)
  s_barrier
  s_lshr_b32 m0, s83, 1
  s_add_u32 m0, m0, 40960
  ds_read_b128 a[64:67], v16 offset:16384
  ds_read_b128 a[68:71], v16 offset:20480
  v_rndne_f32 v74, v73
  v_sub_f32 v73, v73, v74
  v_cos_f32 v74, v73
  v_mfma_f32_32x32x16_bf16 v[144:159], a[36:39], v[112:115], v[144:159]
  ds_read_b128 v[96:99], v20 offset:32768
  ds_read_b128 a[72:75], v17 offset:16384
  buffer_load_dwordx4 v66, s[40:43], s25 offen offset:0 lds
  v_sin_f32 v75, v73
  v_mul_f32 v54, v94, v74
  v_mul_f32 v75, v94, v75
  v_mfma_f32_32x32x16_bf16 v[128:143], a[40:43], v[116:119], v[128:143]
  ds_read_b128 a[76:79], v17 offset:20480
  ds_read_b128 v[100:103], v21 offset:32768
  buffer_load_dwordx4 v67, s[40:43], s25 offen offset:1024 lds
  v_mul_f32 v94, v92, v92
  v_fmac_f32 v94, v93, v93
  v_rcp_f32 v94, v94
  v_mfma_f32_32x32x16_bf16 v[144:159], a[44:47], v[116:119], v[144:159]
  ds_read_b128 a[80:83], v18 offset:16384
  ds_read_b128 a[84:87], v18 offset:20480
  s_add_u32 m0, s83, 147456
  v_add_f32 v73, -1.0, v54
  v_mul_f32 v74, v73, v92
  v_fmac_f32 v74, v75, v93
  v_mfma_f32_32x32x16_bf16 v[128:143], a[48:51], v[120:123], v[128:143]
  ds_read_b128 v[104:107], v22 offset:32768
  ds_read_b128 a[88:91], v19 offset:16384
  buffer_load_dwordx4 v68, s[44:47], s25 offen offset:0 lds
  v_add_f32 v94, v94, v94
  v_mul_f32 v74, v74, v94
  v_mul_f32 v57, v73, v93
  v_fma_f32 v57, -v75, v92, v57
  v_mfma_f32_32x32x16_bf16 v[144:159], a[52:55], v[120:123], v[144:159]
  ds_read_b128 a[92:95], v19 offset:20480
  ds_read_b128 v[108:111], v23 offset:32768
  buffer_load_dwordx4 v69, s[44:47], s25 offen offset:1024 lds
  v_mul_f32 v57, v57, v94
  v_lshlrev_b32 v73, 31, v82
  v_xor_b32 v56, v73, v74
  v_xor_b32 v55, v73, v75
  v_mfma_f32_32x32x16_bf16 v[128:143], a[56:59], v[124:127], v[128:143]
  buffer_load_dwordx4 v70, s[48:51], s25 offen offset:2048 lds
  v_mul_f32 v74, v55, v55
  v_mul_f32 v73, v54, v55
  v_fma_f32 v58, v54, v54, -v74
  v_add_f32 v59, v73, v73
  v_mfma_f32_32x32x16_bf16 v[144:159], a[60:63], v[124:127], v[144:159]
  buffer_load_dwordx4 v71, s[48:51], s25 offen offset:3072 lds
  v_mul_f32 v74, v59, v59
  v_mul_f32 v73, v58, v59
  v_fma_f32 v58, v58, v58, -v74
  s_waitcnt lgkmcnt(0)
  v_mfma_f32_32x32x16_bf16 v[128:143], a[64:67], v[96:99], v[128:143]
  s_waitcnt vmcnt(13)
  s_barrier
  s_lshr_b32 m0, s83, 1
  s_add_u32 m0, m0, 49152
  ds_read_b128 a[96:99], v16 offset:24576
  ds_read_b128 a[100:103], v16 offset:28672
  v_add_f32 v59, v73, v73
  v_mul_f32 v74, v59, v59
  v_mul_f32 v73, v58, v59
  v_fma_f32 v58, v58, v58, -v74
  v_mfma_f32_32x32x16_bf16 v[144:159], a[68:71], v[96:99], v[144:159]
  ds_read_b128 v[112:115], v20 offset:49152
  ds_read_b128 a[104:107], v17 offset:24576
  buffer_load_dwordx4 v66, s[40:43], s26 offen offset:0 lds
  v_add_f32 v59, v73, v73
  v_mul_f32 v74, v59, v59
  v_mul_f32 v73, v58, v59
  v_fma_f32 v58, v58, v58, -v74
  v_mfma_f32_32x32x16_bf16 v[128:143], a[72:75], v[100:103], v[128:143]
  ds_read_b128 a[108:111], v17 offset:28672
  ds_read_b128 v[116:119], v21 offset:49152
  buffer_load_dwordx4 v67, s[40:43], s26 offen offset:1024 lds
  v_add_f32 v59, v73, v73
  v_mul_f32 v74, v59, v59
  v_mul_f32 v73, v58, v59
  v_fma_f32 v60, v58, v58, -v74
  v_mfma_f32_32x32x16_bf16 v[144:159], a[76:79], v[100:103], v[144:159]
  ds_read_b128 a[112:115], v18 offset:24576
  ds_read_b128 a[116:119], v18 offset:28672
  s_add_u32 m0, s83, 65536
  v_add_f32 v61, v73, v73
  v_mul_f32 v74, v61, v61
  v_mul_f32 v73, v60, v61
  v_mfma_f32_32x32x16_bf16 v[128:143], a[80:83], v[104:107], v[128:143]
  ds_read_b128 v[120:123], v22 offset:49152
  ds_read_b128 a[120:123], v19 offset:24576
  buffer_load_dwordx4 v68, s[44:47], s26 offen offset:0 lds
  v_fma_f32 v62, v60, v60, -v74
  v_add_f32 v63, v73, v73
  v_lshlrev_b32 v73, 31, v82
  v_xor_b32 v49, v73, v63
  v_mfma_f32_32x32x16_bf16 v[144:159], a[84:87], v[104:107], v[144:159]
  ds_read_b128 a[124:127], v19 offset:28672
  ds_read_b128 v[124:127], v23 offset:49152
  buffer_load_dwordx4 v69, s[44:47], s26 offen offset:1024 lds
  v_mul_f32 v74, v49, v49
  v_mul_f32 v73, v62, v49
  v_fma_f32 v92, v62, v62, -v74
  v_add_f32 v93, v73, v73
  v_mfma_f32_32x32x16_bf16 v[128:143], a[88:91], v[108:111], v[128:143]
  buffer_load_dwordx4 v70, s[48:51], s26 offen offset:2048 lds
  v_mul_f32 v74, v93, v93
  v_mul_f32 v73, v92, v93
  v_fma_f32 v92, v92, v92, -v74
  v_add_f32 v93, v73, v73
  v_mfma_f32_32x32x16_bf16 v[144:159], a[92:95], v[108:111], v[144:159]
  buffer_load_dwordx4 v71, s[48:51], s26 offen offset:3072 lds
  v_mul_f32 v74, v93, v93
  v_mul_f32 v73, v92, v93
  v_fma_f32 v92, v92, v92, -v74
  s_waitcnt lgkmcnt(0)
  v_mfma_f32_32x32x16_bf16 v[128:143], a[96:99], v[112:115], v[128:143]
  s_waitcnt vmcnt(12)
  s_barrier
  s_add_u32 m0, s83, 81920
  ds_read_b128 a[128:131], v16 offset:32768
  ds_read_b128 a[132:135], v16 offset:36864
  v_add_f32 v93, v73, v73
  v_mul_f32 v74, v93, v93
  v_mfma_f32_32x32x16_bf16 v[144:159], a[100:103], v[112:115], v[144:159]
  ds_read_b128 v[96:99], v24 offset:0
  ds_read_b128 a[136:139], v17 offset:32768
  buffer_load_dwordx4 v4, s[52:55], s27 offen offset:0 lds
  v_mul_f32 v73, v92, v93
  v_mfma_f32_32x32x16_bf16 v[128:143], a[104:107], v[116:119], v[128:143]
  ds_read_b128 a[140:143], v17 offset:36864
  ds_read_b128 v[100:103], v25 offset:0
  buffer_load_dwordx4 v5, s[52:55], s27 offen offset:1024 lds
  v_fma_f32 v94, v92, v92, -v74
  v_add_f32 v78, v73, v73
  v_mfma_f32_32x32x16_bf16 v[144:159], a[108:111], v[116:119], v[144:159]
  ds_read_b128 a[144:147], v18 offset:32768
  ds_read_b128 a[148:151], v18 offset:36864
  v_cndmask_b32 v92, 1.0, v92, s[18:19]
  v_mfma_f32_32x32x16_bf16 v[128:143], a[112:115], v[120:123], v[128:143]
  ds_read_b128 v[104:107], v26 offset:0
  ds_read_b128 a[152:155], v19 offset:32768
  buffer_load_dwordx4 v6, s[52:55], s27 offen offset:2048 lds
  v_cndmask_b32 v93, 0, v93, s[18:19]
  v_cmp_lt_u32 vcc, 31, v0
  s_nop 1
  v_cndmask_b32 v58, 1.0, v58, vcc
  v_cndmask_b32 v59, 0, v59, vcc
  v_cndmask_b32 v94, 1.0, v94, vcc
  v_cndmask_b32 v78, 0, v78, vcc
  v_mfma_f32_32x32x16_bf16 v[144:159], a[116:119], v[120:123], v[144:159]
  ds_read_b128 a[156:159], v19 offset:36864
  ds_read_b128 v[108:111], v27 offset:0
  v_mfma_f32_32x32x16_bf16 v[128:143], a[120:123], v[124:127], v[128:143]
  buffer_load_dwordx4 v7, s[52:55], s27 offen offset:3072 lds
  v_mfma_f32_32x32x16_bf16 v[144:159], a[124:127], v[124:127], v[144:159]
  s_waitcnt lgkmcnt(0)
  v_mfma_f32_32x32x16_bf16 v[128:143], a[128:131], v[96:99], v[128:143]
  s_waitcnt vmcnt(10)
  s_barrier
  s_add_u32 m0, s83, 98304
  ds_read_b128 a[160:163], v16 offset:40960
  ds_read_b128 a[164:167], v16 offset:45056
  v_mul_f32 v74, v93, v78
  s_mov_b32 s44, 0x21654321
  s_mov_b32 s3, 0x20000
L_chk1:
  v_cmp_eq_u32 vcc, 0, v230
  s_nop 4
  s_cbranch_vccnz L_slow1
L_ok1:
  v_mul_f32 v73, v92, v78
  s_mov_b32 s45, 0x6543
  v_readfirstlane_b32 s86, v230
  v_fma_f32 v73, v93, v94, v73
  v_mfma_f32_32x32x16_bf16 v[144:159], a[132:135], v[96:99], v[144:159]
  ds_read_b128 v[112:115], v24 offset:16384
  ds_read_b128 a[168:171], v17 offset:40960
  buffer_load_dwordx4 v4, s[52:55], s28 offen offset:0 lds
  s_getreg_b32 s26, hwreg(HW_REG_XCC_ID, 0, 4)
  s_lshl_b32 s48, s12, 2
  v_fma_f32 v64, v92, v94, -v74
  s_lshl_b32 s17, s80, 10
  s_add_u32 s17, s17, 458752
  v_mov_b32 v65, v73
  s_lshr_b64 s[44:45], s[44:45], s48
  v_mfma_f32_32x32x16_bf16 v[128:143], a[136:139], v[100:103], v[128:143]
  ds_read_b128 a[172:175], v17 offset:45056
  ds_read_b128 v[116:119], v25 offset:16384
  buffer_load_dwordx4 v5, s[52:55], s28 offen offset:1024 lds
  s_lshl1_add_u32 s26, s26, s86
  v_bfe_u32 v74, v82, 3, 1
  s_mov_b32 s3, 0x10001
  s_lshr_b32 s48, s82, 1
  v_cmp_eq_u32 vcc, v74, v83
  v_lshlrev_b32 v74, v88, v95
  s_nop 0
  v_cndmask_b32 v74, 0, v74, vcc
  v_mfma_f32_32x32x16_bf16 v[144:159], a[140:143], v[100:103], v[144:159]
  ds_read_b128 a[176:179], v18 offset:40960
  ds_read_b128 a[180:183], v18 offset:45056
  s_lshl2_add_u32 s46, s48, 0x40000
  s_xor_b32 s47, s46, 4
  v_mfma_f32_32x32x16_bf16 v[128:143], a[144:147], v[104:107], v[128:143]
  ds_read_b128 v[120:123], v26 offset:16384
  ds_read_b128 a[184:187], v19 offset:40960
  buffer_load_dwordx4 v6, s[52:55], s28 offen offset:2048 lds
  v_lshrrev_b32 v75, 4, v82
  s_mul_i32 s48, s48, 28672
  v_bfe_u32 v73, v82, 1, 2
  v_lshl_add_u32 v75, v75, 2, v73
  s_bfe_u32 s45, s44, s46
  v_mfma_f32_32x32x16_bf16 v[144:159], a[148:151], v[104:107], v[144:159]
  ds_read_b128 a[188:191], v19 offset:45056
  ds_read_b128 v[124:127], v27 offset:16384
  v_cmp_eq_u32 vcc, 0, v75
  s_nop 1
  v_cndmask_b32 v73, 0, v74, vcc
  s_add_u32 s49, s81, s45
  v_mfma_f32_32x32x16_bf16 v[128:143], a[152:155], v[108:111], v[128:143]
  buffer_load_dwordx4 v7, s[52:55], s28 offen offset:3072 lds
  s_add_u32 s45, s46, 8
  v_accvgpr_write_b32 a232, v73
  v_cmp_eq_u32 vcc, 1, v75
  s_nop 1
  v_cndmask_b32 v73, 0, v74, vcc
  s_bfe_u32 s45, s44, s45
  v_mfma_f32_32x32x16_bf16 v[144:159], a[156:159], v[108:111], v[144:159]
  s_add_u32 s49, s49, s45
  v_accvgpr_write_b32 a233, v73
  s_waitcnt lgkmcnt(0)
  v_mfma_f32_32x32x16_bf16 v[128:143], a[160:163], v[112:115], v[128:143]
  s_waitcnt vmcnt(8)
  s_barrier
  s_add_u32 m0, s83, 114688
  ds_read_b128 a[192:195], v16 offset:49152
  ds_read_b128 a[196:199], v16 offset:53248
  v_cmp_eq_u32 vcc, 2, v75
  s_nop 1
  v_cndmask_b32 v73, 0, v74, vcc
  ds_read_b128 a[244:247], v76
  v_accvgpr_write_b32 a234, v73
  v_mfma_f32_32x32x16_bf16 v[144:159], a[164:167], v[112:115], v[144:159]
  ds_read_b128 v[96:99], v20 offset:0
  ds_read_b128 a[200:203], v17 offset:49152
  buffer_load_dwordx4 v4, s[52:55], s29 offen offset:0 lds
  v_cmp_eq_u32 vcc, 3, v75
  s_nop 1
  v_cndmask_b32 v73, 0, v74, vcc
  v_mfma_f32_32x32x16_bf16 v[128:143], a[168:171], v[116:119], v[128:143]
  ds_read_b128 a[204:207], v17 offset:53248
  ds_read_b128 v[100:103], v21 offset:0
  buffer_load_dwordx4 v5, s[52:55], s29 offen offset:1024 lds
  v_accvgpr_write_b32 a235, v73
  ds_read_b128 a[248:251], v77
  v_cmp_eq_u32 vcc, 4, v75
  s_nop 1
  v_cndmask_b32 v73, 0, v74, vcc
  v_mfma_f32_32x32x16_bf16 v[144:159], a[172:175], v[116:119], v[144:159]
  ds_read_b128 a[208:211], v18 offset:49152
  ds_read_b128 a[212:215], v18 offset:53248
  v_accvgpr_write_b32 a236, v73
  v_cmp_eq_u32 vcc, 5, v75
  s_nop 1
  v_cndmask_b32 v73, 0, v74, vcc
  v_mfma_f32_32x32x16_bf16 v[128:143], a[176:179], v[120:123], v[128:143]
  ds_read_b128 v[104:107], v22 offset:0
  ds_read_b128 a[216:219], v19 offset:49152
  buffer_load_dwordx4 v6, s[52:55], s29 offen offset:2048 lds
  s_cmp_eq_u32 s91, 0
  s_cselect_b32 s40, s60, s64
  s_cselect_b32 s41, s61, s65
  v_accvgpr_write_b32 a237, v73
  v_cmp_eq_u32 vcc, 6, v75
  s_nop 1
  v_cndmask_b32 v73, 0, v74, vcc
  v_mfma_f32_32x32x16_bf16 v[144:159], a[180:183], v[120:123], v[144:159]
  ds_read_b128 a[220:223], v19 offset:53248
  ds_read_b128 v[108:111], v23 offset:0
  s_mov_b32 s42, 400640
  v_accvgpr_write_b32 a238, v73
  s_sub_u32 s90, 0, s90
  v_mfma_f32_32x32x16_bf16 v[128:143], a[184:187], v[124:127], v[128:143]
  buffer_load_dwordx4 v7, s[52:55], s29 offen offset:3072 lds
  v_cmp_eq_u32 vcc, 7, v75
  s_nop 1
  v_cndmask_b32 v73, 0, v74, vcc
  s_mov_b32 s51, s90
  s_lshl_b32 s90, s90, 9
  v_accvgpr_write_b32 a239, v73
  v_mfma_f32_32x32x16_bf16 v[144:159], a[188:191], v[124:127], v[144:159]
  s_add_u32 s90, s90, 256
  v_lshl_or_b32 v73, v79, 16, v79
  s_mov_b32 s88, 0x20000
  v_accvgpr_write_b32 a240, v73
  s_waitcnt lgkmcnt(0)
  v_mfma_f32_32x32x16_bf16 v[128:143], a[192:195], v[96:99], v[128:143]
  s_waitcnt vmcnt(8)
  s_barrier
  s_add_u32 m0, s83, 32768
  ds_read_b64_tr_b16 v[112:113], v29 offset:16384
  ds_read_b64_tr_b16 v[114:115], v29 offset:16896
  s_bfe_u32 s45, s44, 262160
  s_add_u32 s49, s49, s45
  v_mfma_f32_32x32x16_bf16 v[144:159], a[196:199], v[96:99], v[144:159]
  ds_read_b64_tr_b16 v[116:117], v29 offset:18432
  buffer_load_dwordx4 v4, s[52:55], s30 offen offset:0 lds
  s_mul_i32 s45, s49, 37
  s_add_u32 s85, s83, 65536
  v_mfma_f32_32x32x16_bf16 v[128:143], a[200:203], v[100:103], v[128:143]
  ds_read_b64_tr_b16 v[118:119], v29 offset:18944
  buffer_load_dwordx4 v5, s[52:55], s30 offen offset:1024 lds
  s_lshr_b32 s45, s45, 8
  v_add_u32 v20, s85, v16
  v_add_u32 v24, 0x10000, v20
  s_mul_i32 s45, s45, 7
  v_add_u32 v21, s85, v17
  v_mfma_f32_32x32x16_bf16 v[144:159], a[204:207], v[100:103], v[144:159]
  ds_read_b64_tr_b16 v[120:121], v29 offset:20480
  ds_read_b64_tr_b16 v[122:123], v29 offset:20992
  v_add_u32 v25, 0x10000, v21
  s_sub_u32 s49, s49, s45
  v_add_u32 v22, s85, v18
  v_mfma_f32_32x32x16_bf16 v[128:143], a[208:211], v[104:107], v[128:143]
  ds_read_b64_tr_b16 v[124:125], v29 offset:22528
  buffer_load_dwordx4 v6, s[52:55], s30 offen offset:2048 lds
  s_lshl_b32 s49, s49, 8
  v_add_u32 v26, 0x10000, v22
  v_add_u32 v23, s85, v19
  s_lshl1_add_u32 s10, s48, s49
  v_mfma_f32_32x32x16_bf16 v[144:159], a[212:215], v[104:107], v[144:159]
  ds_read_b64_tr_b16 v[126:127], v29 offset:23040
  v_add_u32 v27, 0x10000, v23
  s_bfe_u32 s45, s44, s46
  s_and_b32 s85, s83, 4096
  s_add_u32 s85, s85, 0
  v_mfma_f32_32x32x16_bf16 v[128:143], a[216:219], v[108:111], v[128:143]
  buffer_load_dwordx4 v7, s[52:55], s30 offen offset:3072 lds
  s_add_u32 s49, s81, s45
  v_add_u32 v16, s85, v16
  s_add_u32 s45, s47, 8
  v_add_u32 v17, s85, v17
  v_mfma_f32_32x32x16_bf16 v[144:159], a[220:223], v[108:111], v[144:159]
  v_add_u32 v18, s85, v18
  s_bfe_u32 s45, s44, s45
  v_add_u32 v19, s85, v19
  s_waitcnt lgkmcnt(0)
  v_mfma_f32_32x32x16_bf16 v[160:175], v[112:115], a[0:3], 0
  s_waitcnt vmcnt(8)
  s_barrier
  s_add_u32 m0, s83, 49152
  ds_read_b64_tr_b16 v[96:97], v29 offset:32768
  ds_read_b64_tr_b16 v[98:99], v29 offset:33280
  v_mfma_f32_32x32x16_bf16 v[176:191], v[112:115], a[4:7], 0
  ds_read_b64_tr_b16 v[100:101], v29 offset:34816
  buffer_load_dwordx4 v4, s[52:55], s31 offen offset:0 lds
  v_fma_f32 v73, v54, v128, v129
  v_fma_f32 v75, v54, v144, v145
  v_fmac_f32_dpp v73, v128, -v55 quad_perm:[1,0,3,2] row_mask:0xf bank_mask:0xf
  v_fmac_f32_dpp v75, v144, -v55 quad_perm:[1,0,3,2] row_mask:0xf bank_mask:0xf
  v_fma_f32 v72, v54, v73, v130
  v_mfma_f32_32x32x16_bf16 v[160:175], v[116:119], a[8:11], v[160:175]
  ds_read_b64_tr_b16 v[102:103], v29 offset:35328
  buffer_load_dwordx4 v5, s[52:55], s31 offen offset:1024 lds
  v_fma_f32 v74, v54, v75, v146
  v_fmac_f32_dpp v72, v73, -v55 quad_perm:[1,0,3,2] row_mask:0xf bank_mask:0xf
  v_fmac_f32_dpp v74, v75, -v55 quad_perm:[1,0,3,2] row_mask:0xf bank_mask:0xf
  v_fma_f32 v73, v54, v72, v131
  v_fma_f32 v75, v54, v74, v147
  v_fmac_f32_dpp v73, v72, -v55 quad_perm:[1,0,3,2] row_mask:0xf bank_mask:0xf
  v_fmac_f32_dpp v75, v74, -v55 quad_perm:[1,0,3,2] row_mask:0xf bank_mask:0xf
  v_mfma_f32_32x32x16_bf16 v[176:191], v[116:119], a[12:15], v[176:191]
  ds_read_b64_tr_b16 v[104:105], v29 offset:36864
  ds_read_b64_tr_b16 v[106:107], v29 offset:37376
  buffer_load_dwordx4 v6, s[52:55], s31 offen offset:2048 lds
  v_fma_f32 v72, v54, v73, v132
  v_fma_f32 v74, v54, v75, v148
  v_fmac_f32_dpp v72, v73, -v55 quad_perm:[1,0,3,2] row_mask:0xf bank_mask:0xf
  v_fmac_f32_dpp v74, v75, -v55 quad_perm:[1,0,3,2] row_mask:0xf bank_mask:0xf
  v_fma_f32 v73, v54, v72, v133
  v_fma_f32 v75, v54, v74, v149
  v_mfma_f32_32x32x16_bf16 v[160:175], v[120:123], a[16:19], v[160:175]
  ds_read_b64_tr_b16 v[108:109], v29 offset:38912
  buffer_load_dwordx4 v7, s[52:55], s31 offen offset:3072 lds
  v_fmac_f32_dpp v73, v72, -v55 quad_perm:[1,0,3,2] row_mask:0xf bank_mask:0xf
  v_fmac_f32_dpp v75, v74, -v55 quad_perm:[1,0,3,2] row_mask:0xf bank_mask:0xf
  v_fma_f32 v72, v54, v73, v134
  v_fma_f32 v74, v54, v75, v150
  v_fmac_f32_dpp v72, v73, -v55 quad_perm:[1,0,3,2] row_mask:0xf bank_mask:0xf
  v_fmac_f32_dpp v74, v75, -v55 quad_perm:[1,0,3,2] row_mask:0xf bank_mask:0xf
  v_mfma_f32_32x32x16_bf16 v[176:191], v[120:123], a[20:23], v[176:191]
  ds_read_b64_tr_b16 v[110:111], v29 offset:39424
  s_add_u32 m0, s83, 65536
  v_fma_f32 v73, v54, v72, v135
  v_fma_f32 v75, v54, v74, v151
  v_fmac_f32_dpp v73, v72, -v55 quad_perm:[1,0,3,2] row_mask:0xf bank_mask:0xf
  v_fmac_f32_dpp v75, v74, -v55 quad_perm:[1,0,3,2] row_mask:0xf bank_mask:0xf
  v_fma_f32 v72, v54, v73, v136
  v_fma_f32 v74, v54, v75, v152
  v_mfma_f32_32x32x16_bf16 v[160:175], v[124:127], a[24:27], v[160:175]
  buffer_load_dwordx4 v4, s[52:55], s32 offen offset:0 lds
  v_fmac_f32_dpp v72, v73, -v55 quad_perm:[1,0,3,2] row_mask:0xf bank_mask:0xf
  v_fmac_f32_dpp v74, v75, -v55 quad_perm:[1,0,3,2] row_mask:0xf bank_mask:0xf
  v_fma_f32 v73, v54, v72, v137
  v_fma_f32 v75, v54, v74, v153
  v_fmac_f32_dpp v73, v72, -v55 quad_perm:[1,0,3,2] row_mask:0xf bank_mask:0xf
  v_fmac_f32_dpp v75, v74, -v55 quad_perm:[1,0,3,2] row_mask:0xf bank_mask:0xf
  v_mfma_f32_32x32x16_bf16 v[176:191], v[124:127], a[28:31], v[176:191]
  buffer_load_dwordx4 v5, s[52:55], s32 offen offset:1024 lds
  v_fma_f32 v72, v54, v73, v138
  v_fma_f32 v74, v54, v75, v154
  v_fmac_f32_dpp v72, v73, -v55 quad_perm:[1,0,3,2] row_mask:0xf bank_mask:0xf
  v_fmac_f32_dpp v74, v75, -v55 quad_perm:[1,0,3,2] row_mask:0xf bank_mask:0xf
  v_fma_f32 v73, v54, v72, v139
  v_fma_f32 v75, v54, v74, v155
  s_waitcnt lgkmcnt(0)
  v_mfma_f32_32x32x16_bf16 v[160:175], v[96:99], a[32:35], v[160:175]
  s_waitcnt vmcnt(10)
  s_barrier
  s_add_u32 m0, s83, 65536
  ds_read_b64_tr_b16 v[112:113], v29 offset:49152
  ds_read_b64_tr_b16 v[114:115], v29 offset:49664
  v_fmac_f32_dpp v73, v72, -v55 quad_perm:[1,0,3,2] row_mask:0xf bank_mask:0xf
  v_fmac_f32_dpp v75, v74, -v55 quad_perm:[1,0,3,2] row_mask:0xf bank_mask:0xf
  v_fma_f32 v72, v54, v73, v140
  v_fma_f32 v74, v54, v75, v156
  v_fmac_f32_dpp v72, v73, -v55 quad_perm:[1,0,3,2] row_mask:0xf bank_mask:0xf
  v_fmac_f32_dpp v74, v75, -v55 quad_perm:[1,0,3,2] row_mask:0xf bank_mask:0xf
  v_mfma_f32_32x32x16_bf16 v[176:191], v[96:99], a[36:39], v[176:191]
  ds_read_b64_tr_b16 v[116:117], v29 offset:51200
  buffer_load_dwordx4 v6, s[52:55], s32 offen offset:2048 lds
  v_fma_f32 v73, v54, v72, v141
  v_fma_f32 v75, v54, v74, v157
  v_fmac_f32_dpp v73, v72, -v55 quad_perm:[1,0,3,2] row_mask:0xf bank_mask:0xf
  v_fmac_f32_dpp v75, v74, -v55 quad_perm:[1,0,3,2] row_mask:0xf bank_mask:0xf
  v_fma_f32 v72, v54, v73, v142
  v_mfma_f32_32x32x16_bf16 v[160:175], v[100:103], a[40:43], v[160:175]
  ds_read_b64_tr_b16 v[118:119], v29 offset:51712
  buffer_load_dwordx4 v7, s[52:55], s32 offen offset:3072 lds
  v_fma_f32 v74, v54, v75, v158
  v_fmac_f32_dpp v72, v73, -v55 quad_perm:[1,0,3,2] row_mask:0xf bank_mask:0xf
  v_fmac_f32_dpp v74, v75, -v55 quad_perm:[1,0,3,2] row_mask:0xf bank_mask:0xf
  v_fma_f32 v73, v54, v72, v143
  v_fma_f32 v75, v54, v74, v159
  v_mfma_f32_32x32x16_bf16 v[176:191], v[100:103], a[44:47], v[176:191]
  ds_read_b64_tr_b16 v[120:121], v29 offset:53248
  ds_read_b64_tr_b16 v[122:123], v29 offset:53760
  s_add_u32 m0, s83, 81920
  v_fmac_f32_dpp v73, v72, -v55 quad_perm:[1,0,3,2] row_mask:0xf bank_mask:0xf
  v_fmac_f32_dpp v75, v74, -v55 quad_perm:[1,0,3,2] row_mask:0xf bank_mask:0xf
  v_mov_b32 v66, 0
  v_mul_f32_dpp v72, v73, v57 quad_perm:[1,0,3,2] row_mask:0xf bank_mask:0xf
  v_mul_f32_dpp v76, v75, v57 quad_perm:[1,0,3,2] row_mask:0xf bank_mask:0xf
  v_mfma_f32_32x32x16_bf16 v[160:175], v[104:107], a[48:51], v[160:175]
  ds_read_b64_tr_b16 v[124:125], v29 offset:55296
  buffer_load_dwordx4 v4, s[52:55], s33 offen offset:0 lds
  v_fmac_f32 v72, v56, v73
  v_fmac_f32 v76, v56, v75
  v_mov_b32 v78, s86
  v_mov_b32 v67, 0
  v_mov_b32 v79, s26
  v_mfma_f32_32x32x16_bf16 v[176:191], v[104:107], a[52:55], v[176:191]
  ds_read_b64_tr_b16 v[126:127], v29 offset:55808
  buffer_load_dwordx4 v5, s[52:55], s33 offen offset:1024 lds
  v_permlane32_swap_b32 v66, v72
  v_permlane32_swap_b32 v67, v76
  v_fmac_f32 v72, v58, v66
  v_fmac_f32 v76, v58, v67
  v_fmac_f32_dpp v72, v66, v59 quad_perm:[1,0,3,2] row_mask:0xf bank_mask:0xf
  v_mfma_f32_32x32x16_bf16 v[160:175], v[108:111], a[56:59], v[160:175]
  buffer_load_dwordx4 v6, s[52:55], s33 offen offset:2048 lds
  v_fmac_f32_dpp v76, v67, v59 quad_perm:[1,0,3,2] row_mask:0xf bank_mask:0xf
  v_mov_b32 v74, v72
  s_mul_i32 s91, s86, 6
  s_nop 0
  v_permlane32_swap_b32 v72, v74
  v_fmac_f32 v76, v60, v74
  v_mfma_f32_32x32x16_bf16 v[176:191], v[108:111], a[60:63], v[176:191]
  buffer_load_dwordx4 v7, s[52:55], s33 offen offset:3072 lds
  v_fmac_f32_dpp v76, v74, v61 quad_perm:[1,0,3,2] row_mask:0xf bank_mask:0xf
  v_fmac_f32 v67, v58, v74
  v_fmac_f32_dpp v67, v74, v59 quad_perm:[1,0,3,2] row_mask:0xf bank_mask:0xf
  v_mov_b32_dpp v77, v76 quad_perm:[1,0,3,2] row_mask:0xf bank_mask:0xf
  buffer_store_dwordx4 v[76:79], v52, s[72:75], 0 offen sc1
  s_waitcnt lgkmcnt(0)
  v_mfma_f32_32x32x16_bf16 v[160:175], v[112:115], a[64:67], v[160:175]
  s_waitcnt vmcnt(13)
  s_barrier
  s_add_u32 m0, s83, 98304
  s_add_u32 s52, s52, s90
  s_addc_u32 s53, s53, s51
  ds_read_b64_tr_b16 v[96:97], v28 offset:32768
  ds_read_b64_tr_b16 v[98:99], v28 offset:33280
  v_mul_f32_dpp v1, v128, v57 quad_perm:[1,0,3,2] row_mask:0xf bank_mask:0xf
  v_mul_f32_dpp v2, v129, v57 quad_perm:[1,0,3,2] row_mask:0xf bank_mask:0xf
  v_mfma_f32_32x32x16_bf16 v[176:191], v[112:115], a[68:71], v[176:191]
  ds_read_b64_tr_b16 v[100:101], v28 offset:34816
  buffer_load_dwordx4 v4, s[52:55], s27 offen offset:0 lds
  v_fma_f32 v128, v56, v128, v1
  v_fma_f32 v129, v56, v129, v2
  v_mfma_f32_32x32x16_bf16 v[160:175], v[116:119], a[72:75], v[160:175]
  ds_read_b64_tr_b16 v[102:103], v28 offset:35328
  buffer_load_dwordx4 v5, s[52:55], s27 offen offset:1024 lds
  v_mul_f32_dpp v1, v130, v57 quad_perm:[1,0,3,2] row_mask:0xf bank_mask:0xf
  v_mul_f32_dpp v2, v131, v57 quad_perm:[1,0,3,2] row_mask:0xf bank_mask:0xf
  v_mfma_f32_32x32x16_bf16 v[176:191], v[116:119], a[76:79], v[176:191]
  ds_read_b64_tr_b16 v[104:105], v28 offset:36864
  ds_read_b64_tr_b16 v[106:107], v28 offset:37376
  v_fma_f32 v130, v56, v130, v1
  v_fma_f32 v131, v56, v131, v2
  v_mfma_f32_32x32x16_bf16 v[160:175], v[120:123], a[80:83], v[160:175]
  ds_read_b64_tr_b16 v[108:109], v28 offset:38912
  buffer_load_dwordx4 v6, s[52:55], s27 offen offset:2048 lds
  v_mul_f32_dpp v1, v132, v57 quad_perm:[1,0,3,2] row_mask:0xf bank_mask:0xf
  v_mul_f32_dpp v2, v133, v57 quad_perm:[1,0,3,2] row_mask:0xf bank_mask:0xf
  v_mfma_f32_32x32x16_bf16 v[176:191], v[120:123], a[84:87], v[176:191]
  ds_read_b64_tr_b16 v[110:111], v28 offset:39424
  v_fma_f32 v132, v56, v132, v1
  v_fma_f32 v133, v56, v133, v2
  v_mfma_f32_32x32x16_bf16 v[160:175], v[124:127], a[88:91], v[160:175]
  buffer_load_dwordx4 v7, s[52:55], s27 offen offset:3072 lds
  v_mul_f32_dpp v1, v134, v57 quad_perm:[1,0,3,2] row_mask:0xf bank_mask:0xf
  v_mul_f32_dpp v2, v135, v57 quad_perm:[1,0,3,2] row_mask:0xf bank_mask:0xf
  v_mfma_f32_32x32x16_bf16 v[176:191], v[124:127], a[92:95], v[176:191]
  v_fma_f32 v134, v56, v134, v1
  s_mov_b32 s50, m0
  s_lshr_b32 s85, s83, 2
  s_add_u32 m0, s85, 16384
  s_add_u32 s87, s85, s89
  buffer_load_dwordx4 v42, s[68:71], s87 offen sc1 lds
  s_and_b32 s87, s14, 0xfffff000
  s_add_u32 m0, s85, 20480
  s_add_u32 s87, s87, s85
  buffer_load_dwordx4 v42, s[68:71], s87 offen sc1 lds
  s_mov_b32 m0, s50
  v_fma_f32 v135, v56, v135, v2
  s_waitcnt lgkmcnt(0)
  v_mfma_f32_32x32x16_bf16 v[160:175], v[96:99], a[96:99], v[160:175]
  s_waitcnt vmcnt(15)
  s_barrier
  s_add_u32 m0, s83, 32768
  ds_read_b64_tr_b16 v[112:113], v28 offset:49152
  ds_read_b64_tr_b16 v[114:115], v28 offset:49664
  v_mul_f32_dpp v1, v136, v57 quad_perm:[1,0,3,2] row_mask:0xf bank_mask:0xf
  v_mul_f32_dpp v2, v137, v57 quad_perm:[1,0,3,2] row_mask:0xf bank_mask:0xf
  v_mfma_f32_32x32x16_bf16 v[176:191], v[96:99], a[100:103], v[176:191]
  ds_read_b64_tr_b16 v[116:117], v28 offset:51200
  buffer_load_dwordx4 v4, s[52:55], s28 offen offset:0 lds
  v_fma_f32 v136, v56, v136, v1
  v_fma_f32 v137, v56, v137, v2
  v_mfma_f32_32x32x16_bf16 v[160:175], v[100:103], a[104:107], v[160:175]
  ds_read_b64_tr_b16 v[118:119], v28 offset:51712
  buffer_load_dwordx4 v5, s[52:55], s28 offen offset:1024 lds
  v_mul_f32_dpp v1, v138, v57 quad_perm:[1,0,3,2] row_mask:0xf bank_mask:0xf
  v_mul_lo_u32 v53, v53, s86
  v_mul_f32_dpp v2, v139, v57 quad_perm:[1,0,3,2] row_mask:0xf bank_mask:0xf
  v_mfma_f32_32x32x16_bf16 v[176:191], v[100:103], a[108:111], v[176:191]
  ds_read_b64_tr_b16 v[120:121], v28 offset:53248
  ds_read_b64_tr_b16 v[122:123], v28 offset:53760
  v_fma_f32 v138, v56, v138, v1
  v_fma_f32 v139, v56, v139, v2
  v_mfma_f32_32x32x16_bf16 v[160:175], v[104:107], a[112:115], v[160:175]
  ds_read_b64_tr_b16 v[124:125], v28 offset:55296
  buffer_load_dwordx4 v6, s[52:55], s28 offen offset:2048 lds
  v_mul_f32_dpp v1, v140, v57 quad_perm:[1,0,3,2] row_mask:0xf bank_mask:0xf
  v_mul_f32_dpp v2, v141, v57 quad_perm:[1,0,3,2] row_mask:0xf bank_mask:0xf
  v_mfma_f32_32x32x16_bf16 v[176:191], v[104:107], a[116:119], v[176:191]
  ds_read_b64_tr_b16 v[126:127], v28 offset:55808
  v_fma_f32 v140, v56, v140, v1
  v_fma_f32 v141, v56, v141, v2
  v_mfma_f32_32x32x16_bf16 v[160:175], v[108:111], a[120:123], v[160:175]
  buffer_load_dwordx4 v7, s[52:55], s28 offen offset:3072 lds
  v_mul_f32_dpp v1, v142, v57 quad_perm:[1,0,3,2] row_mask:0xf bank_mask:0xf
  v_mul_f32_dpp v2, v143, v57 quad_perm:[1,0,3,2] row_mask:0xf bank_mask:0xf
  v_mfma_f32_32x32x16_bf16 v[176:191], v[108:111], a[124:127], v[176:191]
  v_fma_f32 v142, v56, v142, v1
  v_fma_f32 v143, v56, v143, v2
  s_waitcnt lgkmcnt(0)
  v_mfma_f32_32x32x16_bf16 v[160:175], v[112:115], a[128:131], v[160:175]
  s_waitcnt vmcnt(15)
  s_barrier
  s_add_u32 m0, s83, 49152
  ds_read_b64_tr_b16 v[96:97], v29 offset:0
  ds_read_b64_tr_b16 v[98:99], v29 offset:512
  v_mul_f32_dpp v1, v144, v57 quad_perm:[1,0,3,2] row_mask:0xf bank_mask:0xf
  s_add_u32 s49, s49, s45
  v_mul_f32_dpp v2, v145, v57 quad_perm:[1,0,3,2] row_mask:0xf bank_mask:0xf
  s_bfe_u32 s45, s44, 262164
  v_mfma_f32_32x32x16_bf16 v[176:191], v[112:115], a[132:135], v[176:191]
  ds_read_b64_tr_b16 v[100:101], v29 offset:2048
  buffer_load_dwordx4 v4, s[52:55], s29 offen offset:0 lds
  v_fma_f32 v144, v56, v144, v1
  s_add_u32 s49, s49, s45
  v_fma_f32 v145, v56, v145, v2
  s_mul_i32 s45, s49, 37
  v_mfma_f32_32x32x16_bf16 v[160:175], v[116:119], a[136:139], v[160:175]
  ds_read_b64_tr_b16 v[102:103], v29 offset:2560
  buffer_load_dwordx4 v5, s[52:55], s29 offen offset:1024 lds
  v_mul_f32_dpp v1, v146, v57 quad_perm:[1,0,3,2] row_mask:0xf bank_mask:0xf
  s_lshr_b32 s45, s45, 8
  v_mul_f32_dpp v2, v147, v57 quad_perm:[1,0,3,2] row_mask:0xf bank_mask:0xf
  v_mfma_f32_32x32x16_bf16 v[176:191], v[116:119], a[140:143], v[176:191]
  ds_read_b64_tr_b16 v[104:105], v29 offset:4096
  ds_read_b64_tr_b16 v[106:107], v29 offset:4608
  v_fma_f32 v146, v56, v146, v1
  s_mul_i32 s45, s45, 7
  v_fma_f32 v147, v56, v147, v2
  s_sub_u32 s49, s49, s45
  v_mfma_f32_32x32x16_bf16 v[160:175], v[120:123], a[144:147], v[160:175]
  ds_read_b64_tr_b16 v[108:109], v29 offset:6144
  buffer_load_dwordx4 v6, s[52:55], s29 offen offset:2048 lds
  v_mul_f32_dpp v1, v148, v57 quad_perm:[1,0,3,2] row_mask:0xf bank_mask:0xf
  s_lshl_b32 s49, s49, 8
  v_mul_f32_dpp v2, v149, v57 quad_perm:[1,0,3,2] row_mask:0xf bank_mask:0xf
  s_lshl1_add_u32 s11, s48, s49
  v_mfma_f32_32x32x16_bf16 v[176:191], v[120:123], a[148:151], v[176:191]
  ds_read_b64_tr_b16 v[110:111], v29 offset:6656
  v_fma_f32 v148, v56, v148, v1
  v_fma_f32 v149, v56, v149, v2
  s_add_u32 s11, s11, 28672
  v_mfma_f32_32x32x16_bf16 v[160:175], v[124:127], a[152:155], v[160:175]
  buffer_load_dwordx4 v7, s[52:55], s29 offen offset:3072 lds
  v_mul_f32_dpp v1, v150, v57 quad_perm:[1,0,3,2] row_mask:0xf bank_mask:0xf
  s_add_u32 s45, s46, 8
  v_mul_f32_dpp v2, v151, v57 quad_perm:[1,0,3,2] row_mask:0xf bank_mask:0xf
  s_bfe_u32 s45, s44, s45
  v_mfma_f32_32x32x16_bf16 v[176:191], v[124:127], a[156:159], v[176:191]
  v_fma_f32 v150, v56, v150, v1
  s_add_u32 s49, s81, s45
  v_fma_f32 v151, v56, v151, v2
  s_waitcnt lgkmcnt(0)
  v_mfma_f32_32x32x16_bf16 v[160:175], v[96:99], a[160:163], v[160:175]
  s_waitcnt vmcnt(15)
  s_barrier
  s_add_u32 m0, s83, 65536
  ds_read_b64_tr_b16 v[112:113], v29 offset:16384
  ds_read_b64_tr_b16 v[114:115], v29 offset:16896
  v_mul_f32_dpp v1, v152, v57 quad_perm:[1,0,3,2] row_mask:0xf bank_mask:0xf
  v_mul_f32_dpp v2, v153, v57 quad_perm:[1,0,3,2] row_mask:0xf bank_mask:0xf
  v_mfma_f32_32x32x16_bf16 v[176:191], v[96:99], a[164:167], v[176:191]
  ds_read_b64_tr_b16 v[116:117], v29 offset:18432
  buffer_load_dwordx4 v4, s[52:55], s30 offen offset:0 lds
  v_fma_f32 v152, v56, v152, v1
  v_fma_f32 v153, v56, v153, v2
  v_mfma_f32_32x32x16_bf16 v[160:175], v[100:103], a[168:171], v[160:175]
  ds_read_b64_tr_b16 v[118:119], v29 offset:18944
  buffer_load_dwordx4 v5, s[52:55], s30 offen offset:1024 lds
  v_mul_f32_dpp v1, v154, v57 quad_perm:[1,0,3,2] row_mask:0xf bank_mask:0xf
  s_and_b32 s85, s14, 4095
  v_mul_f32_dpp v2, v155, v57 quad_perm:[1,0,3,2] row_mask:0xf bank_mask:0xf
  v_mfma_f32_32x32x16_bf16 v[176:191], v[100:103], a[172:175], v[176:191]
  ds_read_b64_tr_b16 v[120:121], v29 offset:20480
  ds_read_b64_tr_b16 v[122:123], v29 offset:20992
  v_fma_f32 v154, v56, v154, v1
  v_fma_f32 v155, v56, v155, v2
  v_add_u32 v68, s85, v31
  v_mfma_f32_32x32x16_bf16 v[160:175], v[104:107], a[176:179], v[160:175]
  ds_read_b64_tr_b16 v[124:125], v29 offset:22528
  buffer_load_dwordx4 v6, s[52:55], s30 offen offset:2048 lds
  v_mul_f32_dpp v1, v156, v57 quad_perm:[1,0,3,2] row_mask:0xf bank_mask:0xf
  v_mul_f32_dpp v2, v157, v57 quad_perm:[1,0,3,2] row_mask:0xf bank_mask:0xf
  v_xor_b32 v69, 0x800, v68
  v_mfma_f32_32x32x16_bf16 v[176:191], v[104:107], a[180:183], v[176:191]
  ds_read_b64_tr_b16 v[126:127], v29 offset:23040
  v_fma_f32 v156, v56, v156, v1
  v_fma_f32 v157, v56, v157, v2
  s_lshr_b32 s85, s82, 1
  v_mfma_f32_32x32x16_bf16 v[160:175], v[108:111], a[184:187], v[160:175]
  buffer_load_dwordx4 v7, s[52:55], s30 offen offset:3072 lds
  v_mul_f32_dpp v1, v158, v57 quad_perm:[1,0,3,2] row_mask:0xf bank_mask:0xf
  v_mul_f32_dpp v2, v159, v57 quad_perm:[1,0,3,2] row_mask:0xf bank_mask:0xf
  v_lshl_add_u32 v70, s85, 9, v31
  v_mfma_f32_32x32x16_bf16 v[176:191], v[108:111], a[188:191], v[176:191]
  v_fma_f32 v158, v56, v158, v1
  v_fma_f32 v159, v56, v159, v2
  s_waitcnt lgkmcnt(0)
  v_mfma_f32_32x32x16_bf16 v[160:175], v[112:115], a[192:195], v[160:175]
  s_waitcnt vmcnt(12)
  s_barrier
  s_add_u32 m0, s83, 81920
  ds_read_b64_tr_b16 v[96:97], v29 offset:32768
  ds_read_b128 v[72:75], v31 offset:16384
  ds_read_b128 v[76:79], v31 offset:16896
  v_mfma_f32_32x32x16_bf16 v[176:191], v[112:115], a[196:199], v[176:191]
  ds_read_b64_tr_b16 v[98:99], v29 offset:33280
  buffer_load_dwordx4 v4, s[52:55], s31 offen offset:0 lds
  ds_read_b128 v[80:83], v68 offset:20480
  ds_read_b128 v[84:87], v69 offset:20480
  v_mfma_f32_32x32x16_bf16 v[160:175], v[116:119], a[200:203], v[160:175]
  ds_read_b64_tr_b16 v[100:101], v29 offset:34816
  ds_read_b128 v[88:91], v31 offset:17408
  ds_read_b128 v[92:95], v31 offset:17920
  v_mfma_f32_32x32x16_bf16 v[176:191], v[116:119], a[204:207], v[176:191]
  ds_read_b64_tr_b16 v[102:103], v29 offset:35328
  buffer_load_dwordx4 v5, s[52:55], s31 offen offset:1024 lds
  ds_read_b128 a[252:255], v70 offset:18432
  v_mfma_f32_32x32x16_bf16 v[160:175], v[120:123], a[208:211], v[160:175]
  ds_read_b64_tr_b16 v[104:105], v29 offset:36864
  v_mfma_f32_32x32x16_bf16 v[176:191], v[120:123], a[212:215], v[176:191]
  ds_read_b64_tr_b16 v[106:107], v29 offset:37376
  buffer_load_dwordx4 v6, s[52:55], s31 offen offset:2048 lds
  v_mfma_f32_32x32x16_bf16 v[160:175], v[124:127], a[216:219], v[160:175]
  ds_read_b64_tr_b16 v[108:109], v29 offset:38912
L_chk2:
  s_waitcnt lgkmcnt(3)
  v_accvgpr_read_b32 v2, a255
  v_add3_u32 v1, v75, v79, v91
  v_add3_u32 v1, v1, v95, v83
  v_add3_u32 v1, v1, v87, v2
  v_subrev_u32 v1, s86, v1
  v_cmp_ne_u32 vcc, s91, v1
  s_nop 4
  s_cbranch_vccnz L_slow2
L_ok2:
  v_mov_b32 v75, 0
  v_mov_b32 v79, 0
  v_mov_b32 v83, 0
  v_mov_b32 v87, 0
  v_mfma_f32_32x32x16_bf16 v[176:191], v[124:127], a[220:223], v[176:191]
  ds_read_b64_tr_b16 v[110:111], v29 offset:39424
  buffer_load_dwordx4 v7, s[52:55], s31 offen offset:3072 lds
  v_mfma_f32_32x32x16_bf16 v[160:175], v[80:83], v[72:75], v[160:175]
  v_mfma_f32_32x32x16_bf16 v[176:191], v[80:83], v[76:79], v[176:191]
  s_waitcnt lgkmcnt(0)
  v_mfma_f32_32x32x16_bf16 v[192:207], v[96:99], a[0:3], 0
  s_waitcnt vmcnt(12)
  s_barrier
  s_add_u32 m0, s83, 98304
  ds_read_b64_tr_b16 v[112:113], v28 offset:32768
  ds_read_b64_tr_b16 v[114:115], v28 offset:33280
  v_accvgpr_write_b32 a255, 0
  v_mfma_f32_32x32x16_bf16 v[208:223], v[96:99], a[4:7], 0
  ds_read_b64_tr_b16 v[116:117], v28 offset:34816
  buffer_load_dwordx4 v4, s[52:55], s32 offen offset:0 lds
  v_mul_f32 v68, v160, v160
  v_mul_f32 v69, v161, v161
  v_mul_f32 v70, v162, v162
  v_mfma_f32_32x32x16_bf16 v[192:207], v[100:103], a[8:11], v[192:207]
  ds_read_b64_tr_b16 v[118:119], v28 offset:35328
  buffer_load_dwordx4 v5, s[52:55], s32 offen offset:1024 lds
  v_mul_f32 v71, v163, v163
  v_mul_f32 v80, v164, v164
  v_mul_f32 v81, v165, v165
  v_mul_f32 v82, v166, v166
  v_mul_f32 v83, v167, v167
  v_fma_f32 v68, v68, v88, v89
  v_fma_f32 v69, v69, v88, v89
  v_fma_f32 v70, v70, v88, v89
  v_mfma_f32_32x32x16_bf16 v[208:223], v[100:103], a[12:15], v[208:223]
  ds_read_b64_tr_b16 v[120:121], v28 offset:36864
  ds_read_b64_tr_b16 v[122:123], v28 offset:37376
  v_fma_f32 v71, v71, v88, v89
  v_fma_f32 v80, v80, v88, v89
  v_fma_f32 v81, v81, v88, v89
  v_fma_f32 v82, v82, v88, v89
  v_fma_f32 v83, v83, v88, v89
  v_mul_f32 v68, v68, v160
  v_mul_f32 v69, v69, v161
  v_mfma_f32_32x32x16_bf16 v[192:207], v[104:107], a[16:19], v[192:207]
  ds_read_b64_tr_b16 v[124:125], v28 offset:38912
  buffer_load_dwordx4 v6, s[52:55], s32 offen offset:2048 lds
  v_mul_f32 v70, v70, v162
  v_mul_f32 v71, v71, v163
  v_mul_f32 v80, v80, v164
  v_mul_f32 v81, v81, v165
  v_mul_f32 v82, v82, v166
  v_mul_f32 v83, v83, v167
  v_exp_f32 v68, v68
  v_mfma_f32_32x32x16_bf16 v[208:223], v[104:107], a[20:23], v[208:223]
  ds_read_b64_tr_b16 v[126:127], v28 offset:39424
  v_exp_f32 v69, v69
  v_exp_f32 v70, v70
  v_exp_f32 v71, v71
  v_exp_f32 v80, v80
  v_mfma_f32_32x32x16_bf16 v[192:207], v[108:111], a[24:27], v[192:207]
  buffer_load_dwordx4 v7, s[52:55], s32 offen offset:3072 lds
  v_exp_f32 v81, v81
  v_exp_f32 v82, v82
  v_exp_f32 v83, v83
  v_fma_f32 v68, v68, v90, v90
  v_mfma_f32_32x32x16_bf16 v[208:223], v[108:111], a[28:31], v[208:223]
  v_fma_f32 v69, v69, v90, v90
  v_fma_f32 v70, v70, v90, v90
  v_fma_f32 v71, v71, v90, v90
  v_fma_f32 v80, v80, v90, v90
  v_fma_f32 v81, v81, v90, v90
  v_fma_f32 v82, v82, v90, v90
  v_fma_f32 v83, v83, v90, v90
  s_waitcnt lgkmcnt(0)
  v_mfma_f32_32x32x16_bf16 v[192:207], v[112:115], a[32:35], v[192:207]
  s_waitcnt vmcnt(12)
  s_barrier
  s_add_u32 m0, s83, 32768
  ds_read_b64_tr_b16 v[96:97], v28 offset:49152
  ds_read_b64_tr_b16 v[98:99], v28 offset:49664
  v_rcp_f32 v68, v68
  v_rcp_f32 v69, v69
  v_rcp_f32 v70, v70
  buffer_load_dwordx4 v[224:227], v51, s[72:75], 0 offen offset:0 sc1
  v_mfma_f32_32x32x16_bf16 v[208:223], v[112:115], a[36:39], v[208:223]
  ds_read_b64_tr_b16 v[100:101], v28 offset:51200
  buffer_load_dwordx4 v4, s[52:55], s33 offen offset:0 lds
  v_rcp_f32 v71, v71
  v_rcp_f32 v80, v80
  v_rcp_f32 v81, v81
  v_mfma_f32_32x32x16_bf16 v[192:207], v[116:119], a[40:43], v[192:207]
  ds_read_b64_tr_b16 v[102:103], v28 offset:51712
  v_rcp_f32 v82, v82
  v_rcp_f32 v83, v83
  v_mfma_f32_32x32x16_bf16 v[208:223], v[116:119], a[44:47], v[208:223]
  ds_read_b64_tr_b16 v[104:105], v28 offset:53248
  ds_read_b64_tr_b16 v[106:107], v28 offset:53760
  buffer_load_dwordx4 v5, s[52:55], s33 offen offset:1024 lds
  buffer_load_dwordx4 v[228:231], v51, s[72:75], 0 offen offset:1024 sc1
  v_mul_f32 v68, v68, v160
  v_mul_f32 v69, v69, v161
  v_mul_f32 v70, v70, v162
  v_mul_f32 v71, v71, v163
  v_mul_f32 v80, v80, v164
  v_mfma_f32_32x32x16_bf16 v[192:207], v[120:123], a[48:51], v[192:207]
  ds_read_b64_tr_b16 v[108:109], v28 offset:55296
  v_mul_f32 v81, v81, v165
  v_mul_f32 v82, v82, v166
  v_mul_f32 v83, v83, v167
  v_cvt_pk_bf16_f32 v160, v68, v69
  v_cvt_pk_bf16_f32 v161, v70, v71
  v_mfma_f32_32x32x16_bf16 v[208:223], v[120:123], a[52:55], v[208:223]
  ds_read_b64_tr_b16 v[110:111], v28 offset:55808
  buffer_load_dwordx4 v6, s[52:55], s33 offen offset:2048 lds
  v_cvt_pk_bf16_f32 v162, v80, v81
  v_cvt_pk_bf16_f32 v163, v82, v83
  buffer_load_dwordx4 v[232:235], v51, s[72:75], 0 offen offset:2048 sc1
  v_mul_f32 v68, v176, v176
  v_mul_f32 v69, v177, v177
  v_mfma_f32_32x32x16_bf16 v[192:207], v[124:127], a[56:59], v[192:207]
  v_mul_f32 v70, v178, v178
  v_mul_f32 v71, v179, v179
  ds_write_b128 v35, v[160:163] offset:0
  v_mul_f32 v80, v180, v180
  v_mul_f32 v81, v181, v181
  v_mul_f32 v82, v182, v182
  v_mfma_f32_32x32x16_bf16 v[208:223], v[124:127], a[60:63], v[208:223]
  v_mul_f32 v83, v183, v183
  v_fma_f32 v68, v68, v92, v93
  v_fma_f32 v69, v69, v92, v93
  v_fma_f32 v70, v70, v92, v93
  v_fma_f32 v71, v71, v92, v93
  s_waitcnt lgkmcnt(1)
  v_mfma_f32_32x32x16_bf16 v[192:207], v[96:99], a[64:67], v[192:207]
  s_waitcnt vmcnt(14)
  s_barrier
  s_add_u32 m0, s83, 32768
  ds_read_b64_tr_b16 v[112:113], v29 offset:0
  ds_read_b64_tr_b16 v[114:115], v29 offset:512
  v_fma_f32 v80, v80, v92, v93
  v_fma_f32 v81, v81, v92, v93
  v_fma_f32 v82, v82, v92, v93
  v_fma_f32 v83, v83, v92, v93
  v_mul_f32 v68, v68, v176
  v_mul_f32 v69, v69, v177
  buffer_load_dwordx4 v[236:239], v51, s[72:75], 0 offen offset:3072 sc1
  v_mul_f32 v70, v70, v178
  v_mfma_f32_32x32x16_bf16 v[208:223], v[96:99], a[68:71], v[208:223]
  ds_read_b64_tr_b16 v[116:117], v29 offset:2048
  buffer_load_dwordx4 v7, s[52:55], s33 offen offset:3072 lds
  v_mul_f32 v71, v71, v179
  v_mul_f32 v80, v80, v180
  v_mul_f32 v81, v81, v181
  v_mul_f32 v82, v82, v182
  v_mul_f32 v83, v83, v183
  v_exp_f32 v68, v68
  v_mfma_f32_32x32x16_bf16 v[192:207], v[100:103], a[72:75], v[192:207]
  ds_read_b64_tr_b16 v[118:119], v29 offset:2560
  s_add_u32 m0, s83, 49152
  v_exp_f32 v69, v69
  v_exp_f32 v70, v70
  s_mov_b32 s87, 4096
  buffer_load_dwordx4 v[240:243], v51, s[72:75], s87 offen offset:0 sc1
  v_exp_f32 v71, v71
  v_mfma_f32_32x32x16_bf16 v[208:223], v[100:103], a[76:79], v[208:223]
  ds_read_b64_tr_b16 v[120:121], v29 offset:4096
  ds_read_b64_tr_b16 v[122:123], v29 offset:4608
  v_exp_f32 v80, v80
  v_exp_f32 v81, v81
  v_exp_f32 v82, v82
  v_mfma_f32_32x32x16_bf16 v[192:207], v[104:107], a[80:83], v[192:207]
  ds_read_b64_tr_b16 v[124:125], v29 offset:6144
  buffer_load_dwordx4 v8, s[56:59], s34 offen offset:0 lds
  v_exp_f32 v83, v83
  v_fma_f32 v68, v68, v94, v94
  v_fma_f32 v69, v69, v94, v94
  v_fma_f32 v70, v70, v94, v94
  v_fma_f32 v71, v71, v94, v94
  v_fma_f32 v80, v80, v94, v94
  v_mfma_f32_32x32x16_bf16 v[208:223], v[104:107], a[84:87], v[208:223]
  ds_read_b64_tr_b16 v[126:127], v29 offset:6656
  v_fma_f32 v81, v81, v94, v94
  v_fma_f32 v82, v82, v94, v94
  v_fma_f32 v83, v83, v94, v94
  v_rcp_f32 v68, v68
  v_rcp_f32 v69, v69
  buffer_load_dwordx4 v[244:247], v51, s[72:75], s87 offen offset:1024 sc1
  v_mfma_f32_32x32x16_bf16 v[192:207], v[108:111], a[88:91], v[192:207]
  buffer_load_dwordx4 v9, s[56:59], s34 offen offset:1024 lds
  v_rcp_f32 v70, v70
  v_rcp_f32 v71, v71
  v_rcp_f32 v80, v80
  v_mfma_f32_32x32x16_bf16 v[208:223], v[108:111], a[92:95], v[208:223]
  v_rcp_f32 v81, v81
  v_rcp_f32 v82, v82
  v_rcp_f32 v83, v83
  s_waitcnt lgkmcnt(0)
  v_mfma_f32_32x32x16_bf16 v[192:207], v[112:115], a[96:99], v[192:207]
  s_waitcnt vmcnt(16)
  s_barrier
  s_add_u32 m0, s83, 49152
  ds_read_b64_tr_b16 v[96:97], v29 offset:16384
  ds_read_b64_tr_b16 v[98:99], v29 offset:16896
  v_mul_f32 v68, v68, v176
  v_mul_f32 v69, v69, v177
  v_mul_f32 v70, v70, v178
  v_mul_f32 v71, v71, v179
  v_mul_f32 v80, v80, v180
  buffer_load_dwordx4 v[248:251], v51, s[72:75], s87 offen offset:2048 sc1
  v_mul_f32 v81, v81, v181
  v_mfma_f32_32x32x16_bf16 v[208:223], v[112:115], a[100:103], v[208:223]
  ds_read_b64_tr_b16 v[100:101], v29 offset:18432
  buffer_load_dwordx4 v10, s[56:59], s34 offen offset:2048 lds
  v_mul_f32 v82, v82, v182
  v_mul_f32 v83, v83, v183
  v_cvt_pk_bf16_f32 v176, v68, v69
  v_cvt_pk_bf16_f32 v177, v70, v71
  v_cvt_pk_bf16_f32 v178, v80, v81
  v_cvt_pk_bf16_f32 v179, v82, v83
  v_mfma_f32_32x32x16_bf16 v[192:207], v[116:119], a[104:107], v[192:207]
  ds_read_b64_tr_b16 v[102:103], v29 offset:18944
  v_mul_f32 v68, v168, v168
  v_mul_f32 v69, v169, v169
  v_mul_f32 v70, v170, v170
  v_mul_f32 v71, v171, v171
  v_mfma_f32_32x32x16_bf16 v[208:223], v[116:119], a[108:111], v[208:223]
  ds_read_b64_tr_b16 v[104:105], v29 offset:20480
  ds_read_b64_tr_b16 v[106:107], v29 offset:20992
  v_mul_f32 v80, v172, v172
  v_mul_f32 v81, v173, v173
  v_mul_f32 v82, v174, v174
  v_mul_f32 v83, v175, v175
  v_fma_f32 v68, v68, v88, v89
  v_fma_f32 v69, v69, v88, v89
  v_mfma_f32_32x32x16_bf16 v[192:207], v[120:123], a[112:115], v[192:207]
  ds_read_b64_tr_b16 v[108:109], v29 offset:22528
  buffer_load_dwordx4 v11, s[56:59], s34 offen offset:3072 lds
  v_fma_f32 v70, v70, v88, v89
  buffer_load_dwordx4 v[252:255], v51, s[72:75], s87 offen offset:3072 sc1
  v_fma_f32 v71, v71, v88, v89
  v_fma_f32 v80, v80, v88, v89
  v_fma_f32 v81, v81, v88, v89
  v_fma_f32 v82, v82, v88, v89
  v_fma_f32 v83, v83, v88, v89
  v_mfma_f32_32x32x16_bf16 v[208:223], v[120:123], a[116:119], v[208:223]
  ds_read_b64_tr_b16 v[110:111], v29 offset:23040
  v_mul_f32 v68, v68, v168
  v_mul_f32 v69, v69, v169
  v_mul_f32 v70, v70, v170
  v_mul_f32 v71, v71, v171
  v_mul_f32 v80, v80, v172
  v_mfma_f32_32x32x16_bf16 v[192:207], v[124:127], a[120:123], v[192:207]
  v_mul_f32 v81, v81, v173
  v_mul_f32 v82, v82, v174
  ds_write_b128 v35, v[176:179] offset:8192
  v_mul_f32 v83, v83, v175
  v_exp_f32 v68, v68
  v_exp_f32 v69, v69
  v_mfma_f32_32x32x16_bf16 v[208:223], v[124:127], a[124:127], v[208:223]
  v_exp_f32 v70, v70
  v_exp_f32 v71, v71
  s_waitcnt lgkmcnt(1)
  v_mfma_f32_32x32x16_bf16 v[192:207], v[96:99], a[128:131], v[192:207]
  s_waitcnt vmcnt(16)
  s_barrier
  s_add_u32 m0, s83, 65536
  ds_read_b64_tr_b16 v[112:113], v29 offset:32768
  ds_read_b64_tr_b16 v[114:115], v29 offset:33280
  v_exp_f32 v80, v80
  v_exp_f32 v81, v81
  v_exp_f32 v82, v82
  v_exp_f32 v83, v83
  v_mfma_f32_32x32x16_bf16 v[208:223], v[96:99], a[132:135], v[208:223]
  ds_read_b64_tr_b16 v[116:117], v29 offset:34816
  buffer_load_dwordx4 v8, s[56:59], s36 offen offset:0 lds
  v_fma_f32 v68, v68, v90, v90
  v_fma_f32 v69, v69, v90, v90
  v_fma_f32 v70, v70, v90, v90
  v_fma_f32 v71, v71, v90, v90
  v_fma_f32 v80, v80, v90, v90
  v_mfma_f32_32x32x16_bf16 v[192:207], v[100:103], a[136:139], v[192:207]
  ds_read_b64_tr_b16 v[118:119], v29 offset:35328
  buffer_load_dwordx4 v9, s[56:59], s36 offen offset:1024 lds
  v_fma_f32 v81, v81, v90, v90
  v_fma_f32 v82, v82, v90, v90
  v_fma_f32 v83, v83, v90, v90
  v_rcp_f32 v68, v68
  v_rcp_f32 v69, v69
  v_mfma_f32_32x32x16_bf16 v[208:223], v[100:103], a[140:143], v[208:223]
  ds_read_b64_tr_b16 v[120:121], v29 offset:36864
  ds_read_b64_tr_b16 v[122:123], v29 offset:37376
  v_rcp_f32 v70, v70
  v_rcp_f32 v71, v71
  v_rcp_f32 v80, v80
  v_mfma_f32_32x32x16_bf16 v[192:207], v[104:107], a[144:147], v[192:207]
  ds_read_b64_tr_b16 v[124:125], v29 offset:38912
  buffer_load_dwordx4 v10, s[56:59], s36 offen offset:2048 lds
  v_rcp_f32 v81, v81
  v_rcp_f32 v82, v82
  v_rcp_f32 v83, v83
  v_mfma_f32_32x32x16_bf16 v[208:223], v[104:107], a[148:151], v[208:223]
  ds_read_b64_tr_b16 v[126:127], v29 offset:39424
  v_mul_f32 v68, v68, v168
  v_mul_f32 v69, v69, v169
  v_mul_f32 v70, v70, v170
  v_mul_f32 v71, v71, v171
  v_mul_f32 v80, v80, v172
  v_mul_f32 v81, v81, v173
  v_mfma_f32_32x32x16_bf16 v[192:207], v[108:111], a[152:155], v[192:207]
  buffer_load_dwordx4 v11, s[56:59], s36 offen offset:3072 lds
  v_mul_f32 v82, v82, v174
  v_mul_f32 v83, v83, v175
  v_cvt_pk_bf16_f32 v168, v68, v69
  v_cvt_pk_bf16_f32 v169, v70, v71
  v_cvt_pk_bf16_f32 v170, v80, v81
  v_cvt_pk_bf16_f32 v171, v82, v83
  v_mfma_f32_32x32x16_bf16 v[208:223], v[108:111], a[156:159], v[208:223]
  ds_write_b128 v35, v[168:171] offset:1024
  v_mul_f32 v68, v184, v184
  v_mul_f32 v69, v185, v185
  v_mul_f32 v70, v186, v186
  v_mul_f32 v71, v187, v187
  v_mul_f32 v80, v188, v188
  s_waitcnt lgkmcnt(1)
  v_mfma_f32_32x32x16_bf16 v[192:207], v[112:115], a[160:163], v[192:207]
  s_waitcnt vmcnt(12)
  s_barrier
  s_add_u32 m0, s83, 81920
  ds_read_b64_tr_b16 v[96:97], v28 offset:32768
  ds_read_b64_tr_b16 v[98:99], v28 offset:33280
  v_mul_f32 v81, v189, v189
  v_mul_f32 v82, v190, v190
  v_mul_f32 v83, v191, v191
  v_fma_f32 v68, v68, v92, v93
  v_fma_f32 v69, v69, v92, v93
  v_fma_f32 v70, v70, v92, v93
  v_fma_f32 v71, v71, v92, v93
  v_fma_f32 v80, v80, v92, v93
  v_mfma_f32_32x32x16_bf16 v[208:223], v[112:115], a[164:167], v[208:223]
  ds_read_b64_tr_b16 v[100:101], v28 offset:34816
  buffer_load_dwordx4 v8, s[56:59], s38 offen offset:0 lds
  v_fma_f32 v81, v81, v92, v93
  v_fma_f32 v82, v82, v92, v93
  v_fma_f32 v83, v83, v92, v93
  v_mul_f32 v68, v68, v184
  v_mul_f32 v69, v69, v185
  v_mul_f32 v70, v70, v186
  v_mul_f32 v71, v71, v187
  v_mul_f32 v80, v80, v188
  v_mfma_f32_32x32x16_bf16 v[192:207], v[116:119], a[168:171], v[192:207]
  ds_read_b64_tr_b16 v[102:103], v28 offset:35328
  buffer_load_dwordx4 v9, s[56:59], s38 offen offset:1024 lds
  v_mul_f32 v81, v81, v189
  v_mul_f32 v82, v82, v190
  v_mul_f32 v83, v83, v191
  v_exp_f32 v68, v68
  v_exp_f32 v69, v69
  v_mfma_f32_32x32x16_bf16 v[208:223], v[116:119], a[172:175], v[208:223]
  ds_read_b64_tr_b16 v[104:105], v28 offset:36864
  ds_read_b64_tr_b16 v[106:107], v28 offset:37376
  v_exp_f32 v70, v70
  v_exp_f32 v71, v71
  v_exp_f32 v80, v80
  v_exp_f32 v81, v81
  v_mfma_f32_32x32x16_bf16 v[192:207], v[120:123], a[176:179], v[192:207]
  ds_read_b64_tr_b16 v[108:109], v28 offset:38912
  buffer_load_dwordx4 v10, s[56:59], s38 offen offset:2048 lds
  v_exp_f32 v82, v82
  v_exp_f32 v83, v83
  v_fma_f32 v68, v68, v94, v94
  v_fma_f32 v69, v69, v94, v94
  v_fma_f32 v70, v70, v94, v94
  v_fma_f32 v71, v71, v94, v94
  v_mfma_f32_32x32x16_bf16 v[208:223], v[120:123], a[180:183], v[208:223]
  ds_read_b64_tr_b16 v[110:111], v28 offset:39424
  v_fma_f32 v80, v80, v94, v94
  v_fma_f32 v81, v81, v94, v94
  v_fma_f32 v82, v82, v94, v94
  v_fma_f32 v83, v83, v94, v94
  v_rcp_f32 v68, v68
  v_rcp_f32 v69, v69
  v_mfma_f32_32x32x16_bf16 v[192:207], v[124:127], a[184:187], v[192:207]
  buffer_load_dwordx4 v11, s[56:59], s38 offen offset:3072 lds
  v_rcp_f32 v70, v70
  v_rcp_f32 v71, v71
  v_rcp_f32 v80, v80
  v_rcp_f32 v81, v81
  v_mfma_f32_32x32x16_bf16 v[208:223], v[124:127], a[188:191], v[208:223]
  v_rcp_f32 v82, v82
  v_rcp_f32 v83, v83
  v_mul_f32 v68, v68, v184
  v_mul_f32 v69, v69, v185
  s_waitcnt lgkmcnt(0)
  v_mfma_f32_32x32x16_bf16 v[192:207], v[96:99], a[192:195], v[192:207]
  s_waitcnt vmcnt(9)
  s_barrier
  s_add_u32 m0, s83, 32768
  s_add_u32 s84, s34, 14336
  ds_read_b128 a[0:3], v38 offset:0
  ds_read_b128 a[4:7], v39 offset:0
  s_waitcnt vmcnt(8)
L_chk3:
  v_add_u32 v1, v226, v230
  v_add3_u32 v1, v1, v234, v238
  v_add3_u32 v1, v1, v242, v246
  v_add3_u32 v1, v1, v250, v254
  v_cmp_ne_u32 vcc, v1, v53
  s_nop 4
  s_cbranch_vccnz L_slow3
L_ok3:
  v_mul_f32 v70, v70, v186
  v_fmac_f32 v248, v62, v252
  v_fmac_f32 v249, v62, v253
  v_mul_f32 v71, v71, v187
  v_mfma_f32_32x32x16_bf16 v[208:223], v[96:99], a[196:199], v[208:223]
  ds_read_b64_tr_b16 v[112:113], v32 offset:49152
  ds_read_b64_tr_b16 v[114:115], v32 offset:50176
  buffer_load_dwordx4 v8, s[56:59], s84 offen offset:0 lds
  v_fmac_f32 v248, v49, v253
  v_fma_f32 v249, -v49, v252, v249
  v_mul_f32 v80, v80, v188
  v_mfma_f32_32x32x16_bf16 v[192:207], v[100:103], a[200:203], v[192:207]
  ds_read_b128 a[8:11], v38 offset:2048
  ds_read_b128 a[12:15], v39 offset:2048
  v_fmac_f32 v244, v62, v248
  v_fmac_f32 v245, v62, v249
  v_mul_f32 v81, v81, v189
  v_mfma_f32_32x32x16_bf16 v[208:223], v[100:103], a[204:207], v[208:223]
  ds_read_b64_tr_b16 v[116:117], v32 offset:51200
  ds_read_b64_tr_b16 v[118:119], v32 offset:52224
  buffer_load_dwordx4 v9, s[56:59], s84 offen offset:1024 lds
  v_fmac_f32 v244, v49, v249
  v_fma_f32 v245, -v49, v248, v245
  v_mul_f32 v82, v82, v190
  v_fmac_f32 v240, v62, v244
  v_mfma_f32_32x32x16_bf16 v[192:207], v[104:107], a[208:211], v[192:207]
  ds_read_b128 a[16:19], v38 offset:4096
  ds_read_b128 a[20:23], v39 offset:4096
  v_fmac_f32 v241, v62, v245
  v_mul_f32 v83, v83, v191
  v_fmac_f32 v240, v49, v245
  v_mfma_f32_32x32x16_bf16 v[208:223], v[104:107], a[212:215], v[208:223]
  ds_read_b64_tr_b16 v[120:121], v32 offset:53248
  ds_read_b64_tr_b16 v[122:123], v32 offset:54272
  buffer_load_dwordx4 v10, s[56:59], s84 offen offset:2048 lds
  v_fma_f32 v241, -v49, v244, v241
  v_cvt_pk_bf16_f32 v184, v68, v69
  v_fmac_f32 v236, v62, v240
  v_mfma_f32_32x32x16_bf16 v[192:207], v[108:111], a[216:219], v[192:207]
  ds_read_b128 a[24:27], v38 offset:6144
  ds_read_b128 a[28:31], v39 offset:6144
  v_fmac_f32 v237, v62, v241
  v_cvt_pk_bf16_f32 v185, v70, v71
  v_fmac_f32 v236, v49, v241
  v_fma_f32 v237, -v49, v240, v237
  v_mfma_f32_32x32x16_bf16 v[208:223], v[108:111], a[220:223], v[208:223]
  ds_read_b64_tr_b16 v[124:125], v32 offset:55296
  ds_read_b64_tr_b16 v[126:127], v32 offset:56320
  buffer_load_dwordx4 v11, s[56:59], s84 offen offset:3072 lds
  v_cvt_pk_bf16_f32 v186, v80, v81
  v_fmac_f32 v232, v62, v236
  v_fmac_f32 v233, v62, v237
  v_mfma_f32_32x32x16_bf16 v[192:207], v[84:87], v[72:75], v[192:207]
  v_cvt_pk_bf16_f32 v187, v82, v83
  v_fmac_f32 v232, v49, v237
  v_fma_f32 v233, -v49, v236, v233
  v_mfma_f32_32x32x16_bf16 v[208:223], v[84:87], v[76:79], v[208:223]
  ds_write_b128 v35, v[184:187] offset:9216
  v_fmac_f32 v228, v62, v232
  v_fmac_f32 v229, v62, v233
  s_waitcnt lgkmcnt(1)
  v_mfma_f32_32x32x16_bf16 a[192:207], v[112:115], a[0:3], 0
  s_waitcnt vmcnt(8)
  s_barrier
  s_add_u32 m0, s83, 49152
  s_add_u32 s84, s36, 14336
  ds_read_b64_tr_b16 v[96:97], v33 offset:0
  ds_read_b64_tr_b16 v[98:99], v33 offset:1024
  v_fmac_f32 v228, v49, v233
  v_mul_f32 v68, v192, v192
  v_mul_f32 v69, v193, v193
  v_fma_f32 v229, -v49, v232, v229
  v_mul_f32 v70, v194, v194
  v_mul_f32 v71, v195, v195
  v_fmac_f32 v224, v62, v228
  v_mul_f32 v80, v196, v196
  v_add_u32 v4, 0xffff0000, v20
  v_mul_f32 v81, v197, v197
  v_mfma_f32_32x32x16_bf16 a[208:223], v[112:115], a[4:7], 0
  ds_read_b64_tr_b16 v[100:101], v33 offset:2048
  buffer_load_dwordx4 v8, s[56:59], s84 offen offset:0 lds
  v_fmac_f32 v225, v62, v229
  v_mul_f32 v82, v198, v198
  v_mul_f32 v83, v199, v199
  v_fmac_f32 v224, v49, v229
  v_fma_f32 v68, v68, v88, v89
  v_fma_f32 v69, v69, v88, v89
  v_fma_f32 v225, -v49, v228, v225
  v_fma_f32 v70, v70, v88, v89
  v_mfma_f32_32x32x16_bf16 a[192:207], v[116:119], a[8:11], a[192:207]
  ds_read_b64_tr_b16 v[102:103], v33 offset:3072
  buffer_load_dwordx4 v9, s[56:59], s84 offen offset:1024 lds
  v_fma_f32 v71, v71, v88, v89
  v_mul_f32 v228, v64, v224
  v_fma_f32 v80, v80, v88, v89
  v_fma_f32 v81, v81, v88, v89
  v_mul_f32 v229, v64, v225
  v_add_u32 v5, 0xffff0000, v21
  v_fma_f32 v82, v82, v88, v89
  v_fma_f32 v83, v83, v88, v89
  v_fmac_f32 v228, v65, v225
  v_mul_f32 v68, v68, v192
  v_mfma_f32_32x32x16_bf16 a[208:223], v[116:119], a[12:15], a[208:223]
  ds_read_b64_tr_b16 v[104:105], v33 offset:4096
  ds_read_b64_tr_b16 v[106:107], v33 offset:5120
  v_mul_f32 v69, v69, v193
  v_fma_f32 v229, -v65, v224, v229
  v_mul_f32 v70, v70, v194
  v_mul_f32 v71, v71, v195
  v_cndmask_b32 v2, v229, v228, s[18:19]
  v_mul_f32 v80, v80, v196
  v_mul_f32 v81, v81, v197
  v_mfma_f32_32x32x16_bf16 a[192:207], v[120:123], a[16:19], a[192:207]
  ds_read_b64_tr_b16 v[108:109], v33 offset:6144
  buffer_load_dwordx4 v10, s[56:59], s84 offen offset:2048 lds
  v_cndmask_b32 v1, v228, v229, s[18:19]
  v_mul_f32 v82, v82, v198
  v_mul_f32 v83, v83, v199
  v_add_f32_dpp v1, v2, v1 quad_perm:[1,0,3,2] row_mask:0xf bank_mask:0xf
  v_add_u32 v6, 0xffff0000, v22
  v_exp_f32 v68, v68
  v_mov_b32 v2, v1
  v_exp_f32 v69, v69
  v_mfma_f32_32x32x16_bf16 a[208:223], v[120:123], a[20:23], a[208:223]
  ds_read_b64_tr_b16 v[110:111], v33 offset:7168
  v_permlane32_swap_b32 v1, v2
  v_exp_f32 v70, v70
  v_add_f32 v1, v1, v2
  v_exp_f32 v71, v71
  v_mul_f32 v2, v60, v1
  v_exp_f32 v80, v80
  v_mfma_f32_32x32x16_bf16 a[192:207], v[124:127], a[24:27], a[192:207]
  buffer_load_dwordx4 v11, s[56:59], s84 offen offset:3072 lds
  v_fmac_f32 v66, v58, v1
  v_add_u32 v7, 0xffff0000, v23
  v_exp_f32 v81, v81
  v_fmac_f32_dpp v2, v1, v61 quad_perm:[1,0,3,2] row_mask:0xf bank_mask:0xf
  v_exp_f32 v82, v82
  v_fmac_f32_dpp v66, v1, v59 quad_perm:[1,0,3,2] row_mask:0xf bank_mask:0xf
  v_mfma_f32_32x32x16_bf16 a[208:223], v[124:127], a[28:31], a[208:223]
  v_exp_f32 v83, v83
  v_fmac_f32 v67, v58, v2
  v_fma_f32 v68, v68, v90, v90
  v_fma_f32 v69, v69, v90, v90
  v_fmac_f32_dpp v67, v2, v59 quad_perm:[1,0,3,2] row_mask:0xf bank_mask:0xf
  v_fma_f32 v70, v70, v90, v90
  s_waitcnt lgkmcnt(0)
  v_mfma_f32_32x32x16_bf16 v[224:239], v[96:99], a[0:3], 0
  s_waitcnt vmcnt(8)
  s_barrier
  s_add_u32 m0, s83, 65536
  s_add_u32 s84, s38, 14336
  ds_read_b64_tr_b16 v[112:113], v33 offset:16384
  ds_read_b64_tr_b16 v[114:115], v33 offset:17408
  v_fmac_f32 v128, v54, v66
  v_fma_f32 v71, v71, v90, v90
  v_fmac_f32 v144, v54, v67
  v_fma_f32 v80, v80, v90, v90
  v_fmac_f32_dpp v128, v66, v55 quad_perm:[1,0,3,2] row_mask:0xf bank_mask:0xf
  v_fma_f32 v81, v81, v90, v90
  v_fmac_f32_dpp v144, v67, v55 quad_perm:[1,0,3,2] row_mask:0xf bank_mask:0xf
  v_fma_f32 v82, v82, v90, v90
  v_fmac_f32 v129, v54, v128
  v_fma_f32 v83, v83, v90, v90
  v_mfma_f32_32x32x16_bf16 v[240:255], v[96:99], a[4:7], 0
  ds_read_b64_tr_b16 v[116:117], v33 offset:18432
  buffer_load_dwordx4 v8, s[56:59], s84 offen offset:0 lds
  v_fmac_f32 v145, v54, v144
  v_rcp_f32 v68, v68
  v_fmac_f32_dpp v129, v128, v55 quad_perm:[1,0,3,2] row_mask:0xf bank_mask:0xf
  v_fmac_f32_dpp v145, v144, v55 quad_perm:[1,0,3,2] row_mask:0xf bank_mask:0xf
  v_rcp_f32 v69, v69
  v_fmac_f32 v130, v54, v129
  v_mfma_f32_32x32x16_bf16 v[224:239], v[100:103], a[8:11], v[224:239]
  ds_read_b64_tr_b16 v[118:119], v33 offset:19456
  buffer_load_dwordx4 v9, s[56:59], s84 offen offset:1024 lds
  v_fmac_f32 v146, v54, v145
  v_rcp_f32 v70, v70
  v_fmac_f32_dpp v130, v129, v55 quad_perm:[1,0,3,2] row_mask:0xf bank_mask:0xf
  v_fmac_f32_dpp v146, v145, v55 quad_perm:[1,0,3,2] row_mask:0xf bank_mask:0xf
  v_rcp_f32 v71, v71
  v_cvt_pk_bf16_f32 v128, v128, v129
  v_mfma_f32_32x32x16_bf16 v[240:255], v[100:103], a[12:15], v[240:255]
  ds_read_b64_tr_b16 v[120:121], v33 offset:20480
  ds_read_b64_tr_b16 v[122:123], v33 offset:21504
  v_cvt_pk_bf16_f32 v144, v144, v145
  v_rcp_f32 v80, v80
  v_fmac_f32 v131, v54, v130
  v_fmac_f32 v147, v54, v146
  v_rcp_f32 v81, v81
  v_fmac_f32_dpp v131, v130, v55 quad_perm:[1,0,3,2] row_mask:0xf bank_mask:0xf
  v_mfma_f32_32x32x16_bf16 v[224:239], v[104:107], a[16:19], v[224:239]
  ds_read_b64_tr_b16 v[124:125], v33 offset:22528
  buffer_load_dwordx4 v10, s[56:59], s84 offen offset:2048 lds
  v_fmac_f32_dpp v147, v146, v55 quad_perm:[1,0,3,2] row_mask:0xf bank_mask:0xf
  v_rcp_f32 v82, v82
  v_fmac_f32 v132, v54, v131
  v_fmac_f32 v148, v54, v147
  v_rcp_f32 v83, v83
  v_fmac_f32_dpp v132, v131, v55 quad_perm:[1,0,3,2] row_mask:0xf bank_mask:0xf
  v_fmac_f32_dpp v148, v147, v55 quad_perm:[1,0,3,2] row_mask:0xf bank_mask:0xf
  v_mfma_f32_32x32x16_bf16 v[240:255], v[104:107], a[20:23], v[240:255]
  ds_read_b64_tr_b16 v[126:127], v33 offset:23552
  v_mul_f32 v68, v68, v192
  v_cvt_pk_bf16_f32 v129, v130, v131
  v_mul_f32 v69, v69, v193
  v_cvt_pk_bf16_f32 v145, v146, v147
  v_mul_f32 v70, v70, v194
  v_fmac_f32 v133, v54, v132
  v_mul_f32 v71, v71, v195
  v_fmac_f32 v149, v54, v148
  v_mfma_f32_32x32x16_bf16 v[224:239], v[108:111], a[24:27], v[224:239]
  buffer_load_dwordx4 v11, s[56:59], s84 offen offset:3072 lds
  v_mul_f32 v80, v80, v196
  v_fmac_f32_dpp v133, v132, v55 quad_perm:[1,0,3,2] row_mask:0xf bank_mask:0xf
  v_mul_f32 v81, v81, v197
  v_fmac_f32_dpp v149, v148, v55 quad_perm:[1,0,3,2] row_mask:0xf bank_mask:0xf
  v_mul_f32 v82, v82, v198
  v_fmac_f32 v134, v54, v133
  v_mul_f32 v83, v83, v199
  v_fmac_f32 v150, v54, v149
  v_mfma_f32_32x32x16_bf16 v[240:255], v[108:111], a[28:31], v[240:255]
  v_cvt_pk_bf16_f32 v192, v68, v69
  v_fmac_f32_dpp v134, v133, v55 quad_perm:[1,0,3,2] row_mask:0xf bank_mask:0xf
  v_cvt_pk_bf16_f32 v193, v70, v71
  v_fmac_f32_dpp v150, v149, v55 quad_perm:[1,0,3,2] row_mask:0xf bank_mask:0xf
  v_cvt_pk_bf16_f32 v194, v80, v81
  v_cvt_pk_bf16_f32 v130, v132, v133
  v_cvt_pk_bf16_f32 v195, v82, v83
  v_cvt_pk_bf16_f32 v146, v148, v149
  s_waitcnt lgkmcnt(0)
  v_mfma_f32_32x32x16_bf16 v[160:175], v[112:115], a[0:3], 0
  s_waitcnt vmcnt(8)
  s_barrier
  s_add_u32 m0, s83, 81920
  ds_read_b128 a[32:35], v38 offset:1024
  ds_read_b128 a[36:39], v39 offset:1024
  ds_read_b64_tr_b16 v[96:97], v32 offset:32768
  v_fmac_f32 v135, v54, v134
  v_fmac_f32 v151, v54, v150
  v_mul_f32 v68, v208, v208
  v_mfma_f32_32x32x16_bf16 v[176:191], v[112:115], a[4:7], 0
  ds_read_b64_tr_b16 v[98:99], v32 offset:33792
  ds_read_b128 a[40:43], v38 offset:3072
  ds_read_b128 a[44:47], v39 offset:3072
  buffer_load_dwordx4 v12, s[60:63], s4 offen offset:0 lds
  v_fmac_f32_dpp v135, v134, v55 quad_perm:[1,0,3,2] row_mask:0xf bank_mask:0xf
  v_mul_f32 v69, v209, v209
  v_fmac_f32_dpp v151, v150, v55 quad_perm:[1,0,3,2] row_mask:0xf bank_mask:0xf
  v_mul_f32 v70, v210, v210
  v_mfma_f32_32x32x16_bf16 v[160:175], v[116:119], a[8:11], v[160:175]
  ds_read_b64_tr_b16 v[100:101], v32 offset:34816
  ds_read_b64_tr_b16 v[102:103], v32 offset:35840
  buffer_load_dwordx4 v13, s[60:63], s4 offen offset:1024 lds
  v_fmac_f32 v136, v54, v135
  v_mul_f32 v71, v211, v211
  v_fmac_f32 v152, v54, v151
  v_mfma_f32_32x32x16_bf16 v[176:191], v[116:119], a[12:15], v[176:191]
  ds_read_b128 a[48:51], v38 offset:5120
  ds_read_b128 a[52:55], v39 offset:5120
  ds_read_b64_tr_b16 v[104:105], v32 offset:36864
  v_fmac_f32_dpp v136, v135, v55 quad_perm:[1,0,3,2] row_mask:0xf bank_mask:0xf
  v_mul_f32 v80, v212, v212
  v_fmac_f32_dpp v152, v151, v55 quad_perm:[1,0,3,2] row_mask:0xf bank_mask:0xf
  v_mul_f32 v81, v213, v213
  v_mfma_f32_32x32x16_bf16 v[160:175], v[120:123], a[16:19], v[160:175]
  ds_read_b64_tr_b16 v[106:107], v32 offset:37888
  ds_read_b128 a[56:59], v38 offset:7168
  ds_read_b128 a[60:63], v39 offset:7168
  buffer_load_dwordx4 v14, s[60:63], s4 offen offset:2048 lds
  v_cvt_pk_bf16_f32 v131, v134, v135
  v_mul_f32 v82, v214, v214
  v_cvt_pk_bf16_f32 v147, v150, v151
  v_mul_f32 v83, v215, v215
  v_mfma_f32_32x32x16_bf16 v[176:191], v[120:123], a[20:23], v[176:191]
  ds_read_b64_tr_b16 v[108:109], v32 offset:38912
  ds_read_b64_tr_b16 v[110:111], v32 offset:39936
  v_fmac_f32 v137, v54, v136
  v_fmac_f32 v153, v54, v152
  v_fma_f32 v68, v68, v92, v93
  v_mfma_f32_32x32x16_bf16 v[160:175], v[124:127], a[24:27], v[160:175]
  buffer_load_dwordx4 v15, s[60:63], s4 offen offset:3072 lds
  v_fmac_f32_dpp v137, v136, v55 quad_perm:[1,0,3,2] row_mask:0xf bank_mask:0xf
  v_fma_f32 v69, v69, v92, v93
  ds_write_b128 v35, v[192:195] offset:0
  v_fmac_f32_dpp v153, v152, v55 quad_perm:[1,0,3,2] row_mask:0xf bank_mask:0xf
  v_fma_f32 v70, v70, v92, v93
  v_mfma_f32_32x32x16_bf16 v[176:191], v[124:127], a[28:31], v[176:191]
  ds_write_b128 v40, v[128:131] offset:0
  v_fma_f32 v71, v71, v92, v93
  ds_write_b128 v40, v[144:147] offset:8192
  s_waitcnt lgkmcnt(3)
  v_mfma_f32_32x32x16_bf16 a[192:207], v[96:99], a[32:35], a[192:207]
  s_waitcnt vmcnt(8)
  s_barrier
  s_add_u32 m0, s83, 32768
  ds_read_b64_tr_b16 v[112:113], v32 offset:49152
  ds_read_b64_tr_b16 v[114:115], v32 offset:50176
  v_fmac_f32 v138, v54, v137
  v_fma_f32 v80, v80, v92, v93
  v_fma_f32 v81, v81, v92, v93
  v_fmac_f32 v154, v54, v153
  v_fma_f32 v82, v82, v92, v93
  v_fmac_f32_dpp v138, v137, v55 quad_perm:[1,0,3,2] row_mask:0xf bank_mask:0xf
  v_fma_f32 v83, v83, v92, v93
  v_fmac_f32_dpp v154, v153, v55 quad_perm:[1,0,3,2] row_mask:0xf bank_mask:0xf
  v_mul_f32 v68, v68, v208
  v_mfma_f32_32x32x16_bf16 a[208:223], v[96:99], a[36:39], a[208:223]
  ds_read_b64_tr_b16 v[116:117], v32 offset:51200
  buffer_load_dwordx4 v12, s[64:67], s4 offen offset:0 lds
  v_mul_f32 v69, v69, v209
  v_cvt_pk_bf16_f32 v132, v136, v137
  v_mul_f32 v70, v70, v210
  v_cvt_pk_bf16_f32 v148, v152, v153
  v_mul_f32 v71, v71, v211
  v_fmac_f32 v139, v54, v138
  v_mul_f32 v80, v80, v212
  v_fmac_f32 v155, v54, v154
  v_mul_f32 v81, v81, v213
  v_mfma_f32_32x32x16_bf16 a[192:207], v[100:103], a[40:43], a[192:207]
  ds_read_b64_tr_b16 v[118:119], v32 offset:52224
  buffer_load_dwordx4 v13, s[64:67], s4 offen offset:1024 lds
  v_mul_f32 v82, v82, v214
  v_fmac_f32_dpp v139, v138, v55 quad_perm:[1,0,3,2] row_mask:0xf bank_mask:0xf
  v_mul_f32 v83, v83, v215
  v_fmac_f32_dpp v155, v154, v55 quad_perm:[1,0,3,2] row_mask:0xf bank_mask:0xf
  v_exp_f32 v68, v68
  v_fmac_f32 v140, v54, v139
  v_fmac_f32 v156, v54, v155
  v_exp_f32 v69, v69
  v_mfma_f32_32x32x16_bf16 a[208:223], v[100:103], a[44:47], a[208:223]
  ds_read_b64_tr_b16 v[120:121], v32 offset:53248
  ds_read_b64_tr_b16 v[122:123], v32 offset:54272
  v_fmac_f32_dpp v140, v139, v55 quad_perm:[1,0,3,2] row_mask:0xf bank_mask:0xf
  v_exp_f32 v70, v70
  v_fmac_f32_dpp v156, v155, v55 quad_perm:[1,0,3,2] row_mask:0xf bank_mask:0xf
  v_cvt_pk_bf16_f32 v133, v138, v139
  v_exp_f32 v71, v71
  v_mfma_f32_32x32x16_bf16 a[192:207], v[104:107], a[48:51], a[192:207]
  ds_read_b64_tr_b16 v[124:125], v32 offset:55296
  buffer_load_dwordx4 v14, s[64:67], s4 offen offset:2048 lds
  v_cvt_pk_bf16_f32 v149, v154, v155
  v_exp_f32 v80, v80
  v_fmac_f32 v141, v54, v140
  v_fmac_f32 v157, v54, v156
  v_exp_f32 v81, v81
  v_fmac_f32_dpp v141, v140, v55 quad_perm:[1,0,3,2] row_mask:0xf bank_mask:0xf
  v_mfma_f32_32x32x16_bf16 a[208:223], v[104:107], a[52:55], a[208:223]
  ds_read_b64_tr_b16 v[126:127], v32 offset:56320
  v_exp_f32 v82, v82
  v_fmac_f32_dpp v157, v156, v55 quad_perm:[1,0,3,2] row_mask:0xf bank_mask:0xf
  v_fmac_f32 v142, v54, v141
  v_exp_f32 v83, v83
  v_fmac_f32 v158, v54, v157
  v_fmac_f32_dpp v142, v141, v55 quad_perm:[1,0,3,2] row_mask:0xf bank_mask:0xf
  v_fma_f32 v68, v68, v94, v94
  v_mfma_f32_32x32x16_bf16 a[192:207], v[108:111], a[56:59], a[192:207]
  buffer_load_dwordx4 v15, s[64:67], s4 offen offset:3072 lds
  v_fma_f32 v69, v69, v94, v94
  v_fmac_f32_dpp v158, v157, v55 quad_perm:[1,0,3,2] row_mask:0xf bank_mask:0xf
  v_fma_f32 v70, v70, v94, v94
  v_cvt_pk_bf16_f32 v134, v140, v141
  v_fma_f32 v71, v71, v94, v94
  v_cvt_pk_bf16_f32 v150, v156, v157
  v_fma_f32 v80, v80, v94, v94
  v_fmac_f32 v143, v54, v142
  v_fma_f32 v81, v81, v94, v94
  v_mfma_f32_32x32x16_bf16 a[208:223], v[108:111], a[60:63], a[208:223]
  v_fma_f32 v82, v82, v94, v94
  v_fmac_f32 v159, v54, v158
  v_fma_f32 v83, v83, v94, v94
  v_fmac_f32_dpp v143, v142, v55 quad_perm:[1,0,3,2] row_mask:0xf bank_mask:0xf
  v_rcp_f32 v68, v68
  v_fmac_f32_dpp v159, v158, v55 quad_perm:[1,0,3,2] row_mask:0xf bank_mask:0xf
  s_waitcnt lgkmcnt(0)
  v_mfma_f32_32x32x16_bf16 v[224:239], v[112:115], a[32:35], v[224:239]
  s_waitcnt vmcnt(8)
  s_barrier
  s_add_u32 m0, s83, 49152
  ds_read_b64_tr_b16 v[96:97], v33 offset:0
  ds_read_b64_tr_b16 v[98:99], v33 offset:1024
  v_cvt_pk_bf16_f32 v135, v142, v143
  v_rcp_f32 v69, v69
  v_rcp_f32 v70, v70
  v_rcp_f32 v71, v71
  v_mfma_f32_32x32x16_bf16 v[240:255], v[112:115], a[36:39], v[240:255]
  ds_read_b64_tr_b16 v[100:101], v33 offset:2048
  buffer_load_dwordx4 v8, s[56:59], s35 offen offset:0 lds
  v_rcp_f32 v80, v80
  v_cvt_pk_bf16_f32 v151, v158, v159
  v_rcp_f32 v81, v81
  v_rcp_f32 v82, v82
  v_mfma_f32_32x32x16_bf16 v[224:239], v[116:119], a[40:43], v[224:239]
  ds_read_b64_tr_b16 v[102:103], v33 offset:3072
  buffer_load_dwordx4 v9, s[56:59], s35 offen offset:1024 lds
  v_rcp_f32 v83, v83
  ds_write_b128 v41, v[132:135] offset:0
  v_mul_f32 v68, v68, v208
  v_mul_f32 v69, v69, v209
  v_mul_f32 v70, v70, v210
  v_mfma_f32_32x32x16_bf16 v[240:255], v[116:119], a[44:47], v[240:255]
  ds_read_b64_tr_b16 v[104:105], v33 offset:4096
  ds_read_b64_tr_b16 v[106:107], v33 offset:5120
  v_mul_f32 v71, v71, v211
  v_mul_f32 v80, v80, v212
  v_mul_f32 v81, v81, v213
  v_mul_f32 v82, v82, v214
  ds_write_b128 v41, v[148:151] offset:8192
  v_mul_f32 v83, v83, v215
  v_mfma_f32_32x32x16_bf16 v[224:239], v[120:123], a[48:51], v[224:239]
  ds_read_b64_tr_b16 v[108:109], v33 offset:6144
  buffer_load_dwordx4 v10, s[56:59], s35 offen offset:2048 lds
  v_cvt_pk_bf16_f32 v208, v68, v69
  v_cvt_pk_bf16_f32 v209, v70, v71
  v_cvt_pk_bf16_f32 v210, v80, v81
  v_cvt_pk_bf16_f32 v211, v82, v83
  ds_write_b128 v35, v[208:211] offset:8192
  v_mul_f32 v68, v200, v200
  v_mfma_f32_32x32x16_bf16 v[240:255], v[120:123], a[52:55], v[240:255]
  ds_read_b64_tr_b16 v[110:111], v33 offset:7168
  v_mfma_f32_32x32x16_bf16 v[224:239], v[124:127], a[56:59], v[224:239]
  buffer_load_dwordx4 v11, s[56:59], s35 offen offset:3072 lds
  v_mul_f32 v69, v201, v201
  v_mfma_f32_32x32x16_bf16 v[240:255], v[124:127], a[60:63], v[240:255]
  buffer_load_dword v52, off, s[68:71], s17 offset:896 sc1
  s_waitcnt lgkmcnt(0)
  v_mfma_f32_32x32x16_bf16 v[160:175], v[96:99], a[32:35], v[160:175]
  s_waitcnt vmcnt(9)
  s_barrier
  s_add_u32 m0, s83, 65536
  s_add_u32 s84, s35, 14336
  ds_read_b64_tr_b16 a[128:129], v44 offset:0
  ds_read_b64_tr_b16 a[130:131], v44 offset:256
  ds_read_b64_tr_b16 a[132:133], v45 offset:0
  ds_read_b64_tr_b16 a[134:135], v45 offset:256
  v_mul_f32 v70, v202, v202
  v_mul_f32 v71, v203, v203
  v_mul_f32 v80, v204, v204
  v_mul_f32 v81, v205, v205
  v_mul_f32 v82, v206, v206
  v_mul_f32 v83, v207, v207
  v_fma_f32 v68, v68, v88, v89
  v_mfma_f32_32x32x16_bf16 v[176:191], v[96:99], a[36:39], v[176:191]
  ds_read_b128 v[112:115], v20 offset:16384
  ds_read_b64_tr_b16 a[136:137], v44 offset:1024
  ds_read_b64_tr_b16 a[138:139], v44 offset:1280
  buffer_load_dwordx4 v8, s[56:59], s84 offen offset:0 lds
  v_fma_f32 v69, v69, v88, v89
  v_fma_f32 v70, v70, v88, v89
  v_fma_f32 v71, v71, v88, v89
  v_fma_f32 v80, v80, v88, v89
  v_fma_f32 v81, v81, v88, v89
  v_fma_f32 v82, v82, v88, v89
  v_fma_f32 v83, v83, v88, v89
  v_mfma_f32_32x32x16_bf16 v[160:175], v[100:103], a[40:43], v[160:175]
  ds_read_b64_tr_b16 a[140:141], v45 offset:1024
  ds_read_b64_tr_b16 a[142:143], v45 offset:1280
  ds_read_b128 v[116:119], v21 offset:16384
  buffer_load_dwordx4 v9, s[56:59], s84 offen offset:1024 lds
  v_mul_f32 v68, v68, v200
  v_mul_f32 v69, v69, v201
  v_mul_f32 v70, v70, v202
  v_mul_f32 v71, v71, v203
  v_mul_f32 v80, v80, v204
  v_mul_f32 v81, v81, v205
  v_mul_f32 v82, v82, v206
  v_mfma_f32_32x32x16_bf16 v[176:191], v[100:103], a[44:47], v[176:191]
  ds_read_b64_tr_b16 a[144:145], v44 offset:2048
  ds_read_b64_tr_b16 a[146:147], v44 offset:2304
  ds_read_b64_tr_b16 a[148:149], v45 offset:2048
  ds_read_b64_tr_b16 a[150:151], v45 offset:2304
  v_mul_f32 v83, v83, v207
  v_exp_f32 v68, v68
  v_exp_f32 v69, v69
  v_exp_f32 v70, v70
  v_mfma_f32_32x32x16_bf16 v[160:175], v[104:107], a[48:51], v[160:175]
  ds_read_b128 v[120:123], v22 offset:16384
  ds_read_b64_tr_b16 a[152:153], v44 offset:3072
  ds_read_b64_tr_b16 a[154:155], v44 offset:3328
  buffer_load_dwordx4 v10, s[56:59], s84 offen offset:2048 lds
  v_exp_f32 v71, v71
  v_exp_f32 v80, v80
  v_exp_f32 v81, v81
  v_exp_f32 v82, v82
  v_mfma_f32_32x32x16_bf16 v[176:191], v[104:107], a[52:55], v[176:191]
  ds_read_b64_tr_b16 a[156:157], v45 offset:3072
  ds_read_b64_tr_b16 a[158:159], v45 offset:3328
  ds_read_b128 v[124:127], v23 offset:16384
  v_exp_f32 v83, v83
  v_fma_f32 v68, v68, v90, v90
  v_fma_f32 v69, v69, v90, v90
  v_fma_f32 v70, v70, v90, v90
  v_fma_f32 v71, v71, v90, v90
  v_mfma_f32_32x32x16_bf16 v[160:175], v[108:111], a[56:59], v[160:175]
  buffer_load_dwordx4 v11, s[56:59], s84 offen offset:3072 lds
  v_fma_f32 v80, v80, v90, v90
  v_fma_f32 v81, v81, v90, v90
  v_fma_f32 v82, v82, v90, v90
  v_fma_f32 v83, v83, v90, v90
  v_rcp_f32 v68, v68
  v_rcp_f32 v69, v69
  v_mfma_f32_32x32x16_bf16 v[176:191], v[108:111], a[60:63], v[176:191]
  v_rcp_f32 v70, v70
  v_rcp_f32 v71, v71
  v_rcp_f32 v80, v80
  s_waitcnt lgkmcnt(0)
  v_mfma_f32_32x32x16_bf16 a[192:207], v[112:115], a[128:131], a[192:207]
  s_waitcnt vmcnt(9)
  s_barrier
  s_add_u32 m0, s83, 81920
  ds_read_b64_tr_b16 a[160:161], v46 offset:0
  ds_read_b64_tr_b16 a[162:163], v46 offset:256
  ds_read_b64_tr_b16 a[164:165], v47 offset:0
  ds_read_b64_tr_b16 a[166:167], v47 offset:256
  v_rcp_f32 v81, v81
  v_rcp_f32 v82, v82
  v_mfma_f32_32x32x16_bf16 a[208:223], v[112:115], a[132:135], a[208:223]
  ds_read_b128 v[96:99], v4 offset:32768
  ds_read_b64_tr_b16 a[168:169], v46 offset:1024
  ds_read_b64_tr_b16 a[170:171], v46 offset:1280
  buffer_load_dwordx4 v12, s[60:63], s5 offen offset:0 lds
  v_rcp_f32 v83, v83
  v_mul_f32 v68, v68, v200
  v_mul_f32 v69, v69, v201
  v_mfma_f32_32x32x16_bf16 a[192:207], v[116:119], a[136:139], a[192:207]
  ds_read_b64_tr_b16 a[172:173], v47 offset:1024
  ds_read_b64_tr_b16 a[174:175], v47 offset:1280
  ds_read_b128 v[100:103], v5 offset:32768
  buffer_load_dwordx4 v13, s[60:63], s5 offen offset:1024 lds
  v_mul_f32 v70, v70, v202
  v_mul_f32 v71, v71, v203
  v_mul_f32 v80, v80, v204
  v_mul_f32 v81, v81, v205
  v_mfma_f32_32x32x16_bf16 a[208:223], v[116:119], a[140:143], a[208:223]
  ds_read_b64_tr_b16 a[176:177], v46 offset:2048
  ds_read_b64_tr_b16 a[178:179], v46 offset:2304
  ds_read_b64_tr_b16 a[180:181], v47 offset:2048
  ds_read_b64_tr_b16 a[182:183], v47 offset:2304
  v_mul_f32 v82, v82, v206
  v_mul_f32 v83, v83, v207
  v_cvt_pk_bf16_f32 v200, v68, v69
  v_cvt_pk_bf16_f32 v201, v70, v71
  v_mfma_f32_32x32x16_bf16 a[192:207], v[120:123], a[144:147], a[192:207]
  ds_read_b128 v[104:107], v6 offset:32768
  ds_read_b64_tr_b16 a[184:185], v46 offset:3072
  ds_read_b64_tr_b16 a[186:187], v46 offset:3328
  buffer_load_dwordx4 v14, s[60:63], s5 offen offset:2048 lds
  v_cvt_pk_bf16_f32 v202, v80, v81
  v_cvt_pk_bf16_f32 v203, v82, v83
  ds_write_b128 v35, v[200:203] offset:1024
  v_mul_f32 v68, v216, v216
  v_mfma_f32_32x32x16_bf16 a[208:223], v[120:123], a[148:151], a[208:223]
  ds_read_b64_tr_b16 a[188:189], v47 offset:3072
  ds_read_b64_tr_b16 a[190:191], v47 offset:3328
  ds_read_b128 v[108:111], v7 offset:32768
  v_mul_f32 v69, v217, v217
  v_mul_f32 v70, v218, v218
  v_mul_f32 v71, v219, v219
  v_mul_f32 v80, v220, v220
  v_mul_f32 v81, v221, v221
  v_mul_f32 v82, v222, v222
  v_mul_f32 v83, v223, v223
  v_fma_f32 v68, v68, v92, v93
  v_fma_f32 v69, v69, v92, v93
  v_mfma_f32_32x32x16_bf16 a[192:207], v[124:127], a[152:155], a[192:207]
  buffer_load_dwordx4 v15, s[60:63], s5 offen offset:3072 lds
  v_fma_f32 v70, v70, v92, v93
  v_fma_f32 v71, v71, v92, v93
  v_fma_f32 v80, v80, v92, v93
  v_fma_f32 v81, v81, v92, v93
  v_fma_f32 v82, v82, v92, v93
  v_fma_f32 v83, v83, v92, v93
  v_mul_f32 v68, v68, v216
  v_mul_f32 v69, v69, v217
  v_mul_f32 v70, v70, v218
  v_mfma_f32_32x32x16_bf16 a[208:223], v[124:127], a[156:159], a[208:223]
  v_mul_f32 v71, v71, v219
  v_mul_f32 v80, v80, v220
  v_mul_f32 v81, v81, v221
  v_mul_f32 v82, v82, v222
  v_mul_f32 v83, v83, v223
  v_exp_f32 v68, v68
  v_exp_f32 v69, v69
  s_waitcnt lgkmcnt(0)
  v_mfma_f32_32x32x16_bf16 a[192:207], v[96:99], a[160:163], a[192:207]
  s_waitcnt vmcnt(9)
  s_barrier
  s_add_u32 m0, s83, 32768
  ds_read_b128 a[64:67], v38 offset:0
  ds_read_b128 a[68:71], v39 offset:0
  v_exp_f32 v70, v70
  v_exp_f32 v71, v71
  v_exp_f32 v80, v80
  v_exp_f32 v81, v81
  v_mfma_f32_32x32x16_bf16 a[208:223], v[96:99], a[164:167], a[208:223]
  ds_read_b64_tr_b16 v[112:113], v32 offset:49152
  ds_read_b64_tr_b16 v[114:115], v32 offset:50176
  buffer_load_dwordx4 v12, s[64:67], s5 offen offset:0 lds
  v_exp_f32 v82, v82
  v_exp_f32 v83, v83
  v_fma_f32 v68, v68, v94, v94
  v_fma_f32 v69, v69, v94, v94
  v_fma_f32 v70, v70, v94, v94
  v_mfma_f32_32x32x16_bf16 a[192:207], v[100:103], a[168:171], a[192:207]
  ds_read_b128 a[72:75], v38 offset:2048
  ds_read_b128 a[76:79], v39 offset:2048
  v_fma_f32 v71, v71, v94, v94
  v_fma_f32 v80, v80, v94, v94
  v_fma_f32 v81, v81, v94, v94
  v_fma_f32 v82, v82, v94, v94
  v_fma_f32 v83, v83, v94, v94
  v_rcp_f32 v68, v68
  v_mfma_f32_32x32x16_bf16 a[208:223], v[100:103], a[172:175], a[208:223]
  ds_read_b64_tr_b16 v[116:117], v32 offset:51200
  ds_read_b64_tr_b16 v[118:119], v32 offset:52224
  buffer_load_dwordx4 v13, s[64:67], s5 offen offset:1024 lds
  v_rcp_f32 v69, v69
  v_rcp_f32 v70, v70
  v_rcp_f32 v71, v71
  v_rcp_f32 v80, v80
  v_mfma_f32_32x32x16_bf16 a[192:207], v[104:107], a[176:179], a[192:207]
  ds_read_b128 a[80:83], v38 offset:4096
  v_rcp_f32 v81, v81
  v_rcp_f32 v82, v82
  v_rcp_f32 v83, v83
  v_mfma_f32_32x32x16_bf16 a[208:223], v[104:107], a[180:183], a[208:223]
  ds_read_b128 a[84:87], v39 offset:4096
  ds_read_b64_tr_b16 v[120:121], v32 offset:53248
  v_mul_f32 v68, v68, v216
  v_mul_f32 v69, v69, v217
  v_mul_f32 v70, v70, v218
  v_mul_f32 v71, v71, v219
  v_mul_f32 v80, v80, v220
  v_mul_f32 v81, v81, v221
  v_mul_f32 v82, v82, v222
  v_mul_f32 v83, v83, v223
  v_mfma_f32_32x32x16_bf16 a[192:207], v[108:111], a[184:187], a[192:207]
  ds_read_b64_tr_b16 v[122:123], v32 offset:54272
  ds_read_b128 a[88:91], v38 offset:6144
  buffer_load_dwordx4 v14, s[64:67], s5 offen offset:2048 lds
  v_cvt_pk_bf16_f32 v216, v68, v69
  v_cvt_pk_bf16_f32 v217, v70, v71
  v_cvt_pk_bf16_f32 v218, v80, v81
  v_cvt_pk_bf16_f32 v219, v82, v83
  ds_write_b128 v35, v[216:219] offset:9216
  v_mfma_f32_32x32x16_bf16 a[208:223], v[108:111], a[188:191], a[208:223]
  ds_read_b128 a[92:95], v39 offset:6144
  ds_read_b64_tr_b16 v[124:125], v32 offset:55296
  v_mfma_f32_32x32x16_bf16 v[128:143], a[244:247], a[232:235], 0
  ds_read_b64_tr_b16 v[126:127], v32 offset:56320
  buffer_load_dwordx4 v15, s[64:67], s5 offen offset:3072 lds
  v_mfma_f32_32x32x16_bf16 v[128:143], a[248:251], a[236:239], v[128:143]
  v_mfma_f32_32x32x16_bf16 v[128:143], a[252:255], a[240:243], v[128:143]
  s_waitcnt lgkmcnt(0)
  v_mfma_f32_32x32x16_bf16 a[192:207], v[112:115], a[64:67], a[192:207]
  s_waitcnt vmcnt(8)
  s_barrier
  s_add_u32 m0, s83, 49152
  ds_read_b128 a[96:99], v38 offset:1024
  ds_read_b128 a[100:103], v39 offset:1024
  ds_read_b64_tr_b16 v[96:97], v33 offset:0
  s_add_u32 s45, s46, 16
  s_bfe_u32 s45, s44, s45
  v_mfma_f32_32x32x16_bf16 a[208:223], v[112:115], a[68:71], a[208:223]
  ds_read_b64_tr_b16 v[98:99], v33 offset:1024
  ds_read_b128 a[104:107], v38 offset:3072
  ds_read_b128 a[108:111], v39 offset:3072
  buffer_load_dwordx4 v8, s[56:59], s37 offen offset:0 lds
  s_add_u32 s49, s49, s45
  v_mfma_f32_32x32x16_bf16 a[192:207], v[116:119], a[72:75], a[192:207]
  ds_read_b64_tr_b16 v[100:101], v33 offset:2048
  ds_read_b64_tr_b16 v[102:103], v33 offset:3072
  buffer_load_dwordx4 v9, s[56:59], s37 offen offset:1024 lds
  s_mul_i32 s45, s49, 37
  s_lshr_b32 s45, s45, 8
  v_mfma_f32_32x32x16_bf16 a[208:223], v[116:119], a[76:79], a[208:223]
  ds_read_b128 a[112:115], v38 offset:5120
  ds_read_b128 a[116:119], v39 offset:5120
  ds_read_b64_tr_b16 v[104:105], v33 offset:4096
  s_mul_i32 s45, s45, 7
  v_mfma_f32_32x32x16_bf16 a[192:207], v[120:123], a[80:83], a[192:207]
  ds_read_b64_tr_b16 v[106:107], v33 offset:5120
  ds_read_b128 a[120:123], v38 offset:7168
  ds_read_b128 a[124:127], v39 offset:7168
  buffer_load_dwordx4 v10, s[56:59], s37 offen offset:2048 lds
  s_sub_u32 s49, s49, s45
  s_lshl_b32 s49, s49, 8
  v_mfma_f32_32x32x16_bf16 a[208:223], v[120:123], a[84:87], a[208:223]
  ds_read_b64_tr_b16 v[108:109], v33 offset:6144
  ds_read_b64_tr_b16 v[110:111], v33 offset:7168
  s_add_u32 s20, s49, s48
  v_mfma_f32_32x32x16_bf16 a[192:207], v[124:127], a[88:91], a[192:207]
  buffer_load_dwordx4 v11, s[56:59], s37 offen offset:3072 lds
  s_add_u32 s45, s46, 8
  s_bfe_u32 s45, s44, s45
  v_mfma_f32_32x32x16_bf16 a[208:223], v[124:127], a[92:95], a[208:223]
  s_add_u32 s49, s81, s45
  s_waitcnt lgkmcnt(0)
  v_mfma_f32_32x32x16_bf16 a[192:207], v[96:99], a[96:99], a[192:207]
  s_waitcnt vmcnt(8)
  s_barrier
  s_add_u32 m0, s83, 65536
  s_add_u32 s84, s37, 14336
  ds_read_b128 v[112:115], v20 offset:16384
  s_add_u32 s45, s47, 16
  s_bfe_u32 s45, s44, s45
L_chk4:
  v_subrev_u32 v2, s86, v52
  v_xor_b32 v1, s26, v52
  v_xor_b32 v2, 32, v2
  v_min_u32 v1, v1, v2
  v_cmp_ne_u32 vcc, 0, v1
  s_nop 4
  s_cbranch_vccnz L_slow4
L_ok4:
  v_mfma_f32_32x32x16_bf16 a[208:223], v[96:99], a[100:103], a[208:223]
  ds_read_b128 v[116:119], v21 offset:16384
  buffer_load_dwordx4 v8, s[56:59], s84 offen offset:0 lds
  v_cmp_ne_u32 vcc, s26, v52
  s_nop 3
  s_cmp_eq_u64 vcc, 0
  s_cselect_b32 s16, 1, 0
  s_add_u32 s49, s49, s45
  s_mul_i32 s45, s49, 37
  v_mfma_f32_32x32x16_bf16 a[192:207], v[100:103], a[104:107], a[192:207]
  buffer_load_dwordx4 v9, s[56:59], s84 offen offset:1024 lds
  s_lshr_b32 s45, s45, 8
  v_mfma_f32_32x32x16_bf16 a[208:223], v[100:103], a[108:111], a[208:223]
  ds_read_b128 v[120:123], v22 offset:16384
  s_mul_i32 s45, s45, 7
  s_sub_u32 s49, s49, s45
  v_mfma_f32_32x32x16_bf16 a[192:207], v[104:107], a[112:115], a[192:207]
  ds_read_b128 v[124:127], v23 offset:16384
  buffer_load_dwordx4 v10, s[56:59], s84 offen offset:2048 lds
  s_lshl_b32 s49, s49, 8
  s_sub_u32 s49, s49, s48
  v_mfma_f32_32x32x16_bf16 a[208:223], v[104:107], a[116:119], a[208:223]
  s_add_u32 s21, s49, 86016
  v_mfma_f32_32x32x16_bf16 a[192:207], v[108:111], a[120:123], a[192:207]
  buffer_load_dwordx4 v11, s[56:59], s84 offen offset:3072 lds
  s_add_u32 s45, s46, 16
  s_bfe_u32 s45, s44, s45
  v_mfma_f32_32x32x16_bf16 a[208:223], v[108:111], a[124:127], a[208:223]
  s_add_u32 s49, s81, s45
  s_cmp_eq_u32 s16, 0
  s_cbranch_scc1 L_far
  s_waitcnt lgkmcnt(0)
  v_mfma_f32_32x32x16_bf16 v[224:239], v[112:115], a[128:131], v[224:239]
  s_waitcnt vmcnt(8)
  s_barrier
  s_add_u32 m0, s83, 81920
  ds_read_b128 v[96:99], v4 offset:32768
  v_accvgpr_read_b32 v68, a192
  v_accvgpr_read_b32 v69, a193
  v_mfma_f32_32x32x16_bf16 v[240:255], v[112:115], a[132:135], v[240:255]
  ds_read_b128 v[100:103], v5 offset:32768
  buffer_load_dwordx4 v12, s[60:63], s6 offen offset:0 lds
  v_cvt_pk_bf16_f32 v144, v68, v69
  v_accvgpr_read_b32 v70, a194
  v_accvgpr_read_b32 v71, a195
  v_cvt_pk_bf16_f32 v145, v70, v71
  v_bfi_b32 v144, s3, 1, v144
  v_accvgpr_read_b32 v80, a196
  v_accvgpr_read_b32 v81, a197
  v_cvt_pk_bf16_f32 v146, v80, v81
  v_mfma_f32_32x32x16_bf16 v[224:239], v[116:119], a[136:139], v[224:239]
  buffer_load_dwordx4 v13, s[60:63], s6 offen offset:1024 lds
  v_accvgpr_read_b32 v82, a198
  v_accvgpr_read_b32 v83, a199
  v_cvt_pk_bf16_f32 v147, v82, v83
  buffer_store_dwordx4 v[144:147], v43, s[76:79], s10 offen
  v_accvgpr_read_b32 v68, a200
  v_accvgpr_read_b32 v69, a201
  v_cvt_pk_bf16_f32 v148, v68, v69
  v_accvgpr_read_b32 v70, a202
  v_mfma_f32_32x32x16_bf16 v[240:255], v[116:119], a[140:143], v[240:255]
  ds_read_b128 v[104:107], v6 offset:32768
  v_accvgpr_read_b32 v71, a203
  v_cvt_pk_bf16_f32 v149, v70, v71
  v_bfi_b32 v148, s3, 1, v148
  v_accvgpr_read_b32 v80, a204
  v_accvgpr_read_b32 v81, a205
  v_cvt_pk_bf16_f32 v150, v80, v81
  v_accvgpr_read_b32 v82, a206
  v_mfma_f32_32x32x16_bf16 v[224:239], v[120:123], a[144:147], v[224:239]
  ds_read_b128 v[108:111], v7 offset:32768
  buffer_load_dwordx4 v14, s[60:63], s6 offen offset:2048 lds
  v_accvgpr_read_b32 v83, a207
  v_cvt_pk_bf16_f32 v151, v82, v83
  buffer_store_dwordx4 v[148:151], v50, s[76:79], s10 offen
  v_accvgpr_read_b32 v68, a208
  v_accvgpr_read_b32 v69, a209
  v_cvt_pk_bf16_f32 v152, v68, v69
  v_accvgpr_read_b32 v70, a210
  v_accvgpr_read_b32 v71, a211
  v_mfma_f32_32x32x16_bf16 v[240:255], v[120:123], a[148:151], v[240:255]
  v_cvt_pk_bf16_f32 v153, v70, v71
  v_bfi_b32 v152, s3, 1, v152
  v_accvgpr_read_b32 v80, a212
  v_accvgpr_read_b32 v81, a213
  v_cvt_pk_bf16_f32 v154, v80, v81
  v_accvgpr_read_b32 v82, a214
  v_accvgpr_read_b32 v83, a215
  v_cvt_pk_bf16_f32 v155, v82, v83
  v_mfma_f32_32x32x16_bf16 v[224:239], v[124:127], a[152:155], v[224:239]
  buffer_load_dwordx4 v15, s[60:63], s6 offen offset:3072 lds
  buffer_store_dwordx4 v[152:155], v43, s[76:79], s11 offen
  v_accvgpr_read_b32 v68, a216
  v_accvgpr_read_b32 v69, a217
  v_cvt_pk_bf16_f32 v156, v68, v69
  v_accvgpr_read_b32 v70, a218
  v_accvgpr_read_b32 v71, a219
  v_cvt_pk_bf16_f32 v157, v70, v71
  v_bfi_b32 v156, s3, 1, v156
  v_mfma_f32_32x32x16_bf16 v[240:255], v[124:127], a[156:159], v[240:255]
  v_accvgpr_read_b32 v80, a220
  v_accvgpr_read_b32 v81, a221
  v_cvt_pk_bf16_f32 v158, v80, v81
  v_accvgpr_read_b32 v82, a222
  v_accvgpr_read_b32 v83, a223
  v_cvt_pk_bf16_f32 v159, v82, v83
  buffer_store_dwordx4 v[156:159], v50, s[76:79], s11 offen
  s_waitcnt lgkmcnt(0)
  v_mfma_f32_32x32x16_bf16 v[224:239], v[96:99], a[160:163], v[224:239]
  s_waitcnt vmcnt(12)
  s_barrier
  s_add_u32 m0, s83, 32768
  ds_read_b64_tr_b16 v[112:113], v32 offset:49152
  ds_read_b64_tr_b16 v[114:115], v32 offset:50176
  s_mul_i32 s45, s49, 37
  s_lshr_b32 s45, s45, 8
  v_mfma_f32_32x32x16_bf16 v[240:255], v[96:99], a[164:167], v[240:255]
  ds_read_b64_tr_b16 v[116:117], v32 offset:51200
  buffer_load_dwordx4 v12, s[64:67], s6 offen offset:0 lds
  s_mul_i32 s45, s45, 7
  v_mfma_f32_32x32x16_bf16 v[224:239], v[100:103], a[168:171], v[224:239]
  ds_read_b64_tr_b16 v[118:119], v32 offset:52224
  buffer_load_dwordx4 v13, s[64:67], s6 offen offset:1024 lds
  s_sub_u32 s49, s49, s45
  s_lshl_b32 s49, s49, 8
  v_mfma_f32_32x32x16_bf16 v[240:255], v[100:103], a[172:175], v[240:255]
  ds_read_b64_tr_b16 v[120:121], v32 offset:53248
  ds_read_b64_tr_b16 v[122:123], v32 offset:54272
  s_sub_u32 s23, s49, s48
  v_mfma_f32_32x32x16_bf16 v[224:239], v[104:107], a[176:179], v[224:239]
  ds_read_b64_tr_b16 v[124:125], v32 offset:55296
  buffer_load_dwordx4 v14, s[64:67], s6 offen offset:2048 lds
  s_add_u32 s23, s23, 57344
  s_add_u32 s49, s49, s48
  v_mfma_f32_32x32x16_bf16 v[240:255], v[104:107], a[180:183], v[240:255]
  ds_read_b64_tr_b16 v[126:127], v32 offset:56320
  s_lshl1_add_u32 s22, s48, s49
  v_mfma_f32_32x32x16_bf16 v[224:239], v[108:111], a[184:187], v[224:239]
  buffer_load_dwordx4 v15, s[64:67], s6 offen offset:3072 lds
  s_lshl_b32 s49, s81, 8
  s_lshl1_add_u32 s24, s48, s49
  v_mfma_f32_32x32x16_bf16 v[240:255], v[108:111], a[188:191], v[240:255]
  s_add_u32 s25, s24, 28672
  s_waitcnt lgkmcnt(0)
  v_mfma_f32_32x32x16_bf16 v[224:239], v[112:115], a[64:67], v[224:239]
  s_waitcnt vmcnt(12)
  s_barrier
  s_add_u32 m0, s83, 49152
  ds_read_b64_tr_b16 v[96:97], v33 offset:0
  ds_read_b64_tr_b16 v[98:99], v33 offset:1024
  v_mfma_f32_32x32x16_bf16 v[240:255], v[112:115], a[68:71], v[240:255]
  ds_read_b64_tr_b16 v[100:101], v33 offset:2048
  buffer_load_dwordx4 v8, s[56:59], s39 offen offset:0 lds
  v_mfma_f32_32x32x16_bf16 v[224:239], v[116:119], a[72:75], v[224:239]
  ds_read_b64_tr_b16 v[102:103], v33 offset:3072
  buffer_load_dwordx4 v9, s[56:59], s39 offen offset:1024 lds
  buffer_load_dwordx4 v[192:195], v43, s[76:79], s20 offen sc1
  v_mfma_f32_32x32x16_bf16 v[240:255], v[116:119], a[76:79], v[240:255]
  ds_read_b64_tr_b16 v[104:105], v33 offset:4096
  ds_read_b64_tr_b16 v[106:107], v33 offset:5120
  buffer_load_dwordx4 v[196:199], v50, s[76:79], s20 offen sc1
  v_mfma_f32_32x32x16_bf16 v[224:239], v[120:123], a[80:83], v[224:239]
  ds_read_b64_tr_b16 v[108:109], v33 offset:6144
  buffer_load_dwordx4 v10, s[56:59], s39 offen offset:2048 lds
  buffer_load_dwordx4 v[200:203], v43, s[76:79], s21 offen sc1
  v_mfma_f32_32x32x16_bf16 v[240:255], v[120:123], a[84:87], v[240:255]
  ds_read_b64_tr_b16 v[110:111], v33 offset:7168
  buffer_load_dwordx4 v[204:207], v50, s[76:79], s21 offen sc1
  v_mfma_f32_32x32x16_bf16 v[224:239], v[124:127], a[88:91], v[224:239]
  buffer_load_dwordx4 v11, s[56:59], s39 offen offset:3072 lds
  v_mfma_f32_32x32x16_bf16 v[240:255], v[124:127], a[92:95], v[240:255]
  s_waitcnt lgkmcnt(0)
  v_mfma_f32_32x32x16_bf16 v[224:239], v[96:99], a[96:99], v[224:239]
  s_waitcnt vmcnt(14)
  s_barrier
  s_add_u32 m0, s83, 65536
  s_add_u32 s84, s39, 14336
  ds_read_b128 v[112:115], v20 offset:16384
  v_mfma_f32_32x32x16_bf16 v[240:255], v[96:99], a[100:103], v[240:255]
  ds_read_b128 v[116:119], v21 offset:16384
  buffer_load_dwordx4 v8, s[56:59], s84 offen offset:0 lds
  v_mfma_f32_32x32x16_bf16 v[224:239], v[100:103], a[104:107], v[224:239]
  buffer_load_dwordx4 v9, s[56:59], s84 offen offset:1024 lds
  v_mfma_f32_32x32x16_bf16 v[240:255], v[100:103], a[108:111], v[240:255]
  ds_read_b128 v[120:123], v22 offset:16384
  v_mfma_f32_32x32x16_bf16 v[224:239], v[104:107], a[112:115], v[224:239]
  ds_read_b128 v[124:127], v23 offset:16384
  buffer_load_dwordx4 v10, s[56:59], s84 offen offset:2048 lds
  v_mfma_f32_32x32x16_bf16 v[240:255], v[104:107], a[116:119], v[240:255]
  v_mfma_f32_32x32x16_bf16 v[224:239], v[108:111], a[120:123], v[224:239]
  buffer_load_dwordx4 v11, s[56:59], s84 offen offset:3072 lds
  v_mfma_f32_32x32x16_bf16 v[240:255], v[108:111], a[124:127], v[240:255]
  s_waitcnt lgkmcnt(0)
  v_mfma_f32_32x32x16_bf16 v[160:175], v[112:115], a[128:131], v[160:175]
  s_waitcnt vmcnt(12)
  s_barrier
  s_add_u32 m0, s83, 81920
  ds_read_b128 v[96:99], v4 offset:32768
  s_nop 3
  v_cvt_pk_bf16_f32 v144, v224, v225
  v_mfma_f32_32x32x16_bf16 v[176:191], v[112:115], a[132:135], v[176:191]
  ds_read_b128 v[100:103], v5 offset:32768
  buffer_load_dwordx4 v8, s[56:59], s8 offen offset:0 lds
  v_cvt_pk_bf16_f32 v145, v226, v227
  v_bfi_b32 v144, s3, -2, v144
  v_cvt_pk_bf16_f32 v146, v228, v229
  v_cvt_pk_bf16_f32 v147, v230, v231
  v_mfma_f32_32x32x16_bf16 v[160:175], v[116:119], a[136:139], v[160:175]
  buffer_load_dwordx4 v9, s[56:59], s8 offen offset:1024 lds
  v_cvt_pk_bf16_f32 v148, v232, v233
  v_cvt_pk_bf16_f32 v149, v234, v235
  v_bfi_b32 v148, s3, -2, v148
  v_mfma_f32_32x32x16_bf16 v[176:191], v[116:119], a[140:143], v[176:191]
  ds_read_b128 v[104:107], v6 offset:32768
  v_cvt_pk_bf16_f32 v150, v236, v237
  v_cvt_pk_bf16_f32 v151, v238, v239
  v_cvt_pk_bf16_f32 v152, v240, v241
  v_cvt_pk_bf16_f32 v153, v242, v243
  v_mfma_f32_32x32x16_bf16 v[160:175], v[120:123], a[144:147], v[160:175]
  ds_read_b128 v[108:111], v7 offset:32768
  buffer_load_dwordx4 v10, s[56:59], s8 offen offset:2048 lds
  v_bfi_b32 v152, s3, -2, v152
  v_cvt_pk_bf16_f32 v154, v244, v245
  v_cvt_pk_bf16_f32 v155, v246, v247
  v_mfma_f32_32x32x16_bf16 v[176:191], v[120:123], a[148:151], v[176:191]
  v_cvt_pk_bf16_f32 v156, v248, v249
  v_cvt_pk_bf16_f32 v157, v250, v251
  v_bfi_b32 v156, s3, -2, v156
  v_cvt_pk_bf16_f32 v158, v252, v253
  v_mfma_f32_32x32x16_bf16 v[160:175], v[124:127], a[152:155], v[160:175]
  buffer_load_dwordx4 v11, s[56:59], s8 offen offset:3072 lds
  v_cvt_pk_bf16_f32 v159, v254, v255
  s_waitcnt vmcnt(9)
L_chk5:
  v_bitop3_b32 v1, v192, v196, v200 bitop3:0x80
  v_bitop3_b32 v1, v1, v204, s3 bitop3:0x80
  v_cmp_ne_u32 vcc, 1, v1
  s_nop 4
  s_cbranch_vccnz L_slow5
L_ok5:
  buffer_store_dwordx4 v[144:147], v43, s[76:79], s20 offen
  v_mfma_f32_32x32x16_bf16 v[176:191], v[124:127], a[156:159], v[176:191]
  buffer_store_dwordx4 v[148:151], v50, s[76:79], s20 offen
  buffer_store_dwordx4 v[152:155], v43, s[76:79], s21 offen
  buffer_store_dwordx4 v[156:159], v50, s[76:79], s21 offen
  s_waitcnt lgkmcnt(0)
  v_mfma_f32_32x32x16_bf16 v[160:175], v[96:99], a[160:163], v[160:175]
  s_waitcnt vmcnt(12)
  s_barrier
  s_add_u32 m0, s83, 32768
  ds_read_b64_tr_b16 v[112:113], v32 offset:49152
  v_mfma_f32_32x32x16_bf16 v[176:191], v[96:99], a[164:167], v[176:191]
  ds_read_b64_tr_b16 v[114:115], v32 offset:50176
  buffer_load_dwordx4 v8, s[56:59], s9 offen offset:0 lds
  v_mfma_f32_32x32x16_bf16 v[160:175], v[100:103], a[168:171], v[160:175]
  ds_read_b64_tr_b16 v[116:117], v32 offset:51200
  v_mfma_f32_32x32x16_bf16 v[176:191], v[100:103], a[172:175], v[176:191]
  ds_read_b64_tr_b16 v[118:119], v32 offset:52224
  buffer_load_dwordx4 v9, s[56:59], s9 offen offset:1024 lds
  v_mfma_f32_32x32x16_bf16 v[160:175], v[104:107], a[176:179], v[160:175]
  v_mfma_f32_32x32x16_bf16 v[176:191], v[104:107], a[180:183], v[176:191]
  ds_read_b64_tr_b16 v[120:121], v32 offset:53248
  v_mfma_f32_32x32x16_bf16 v[160:175], v[108:111], a[184:187], v[160:175]
  ds_read_b64_tr_b16 v[122:123], v32 offset:54272
  buffer_load_dwordx4 v10, s[56:59], s9 offen offset:2048 lds
  v_mfma_f32_32x32x16_bf16 v[176:191], v[108:111], a[188:191], v[176:191]
  ds_read_b64_tr_b16 v[124:125], v32 offset:55296
  v_mfma_f32_32x32x16_bf16 v[128:143], v[192:195], a[224:227], v[128:143]
  ds_read_b64_tr_b16 v[126:127], v32 offset:56320
  v_mfma_f32_32x32x16_bf16 v[128:143], v[196:199], a[228:231], v[128:143]
  buffer_load_dwordx4 v11, s[56:59], s9 offen offset:3072 lds
  v_mfma_f32_32x32x16_bf16 v[128:143], v[200:203], a[224:227], v[128:143]
  v_mfma_f32_32x32x16_bf16 v[128:143], v[204:207], a[228:231], v[128:143]
  s_waitcnt lgkmcnt(0)
  v_mfma_f32_32x32x16_bf16 v[160:175], v[112:115], a[64:67], v[160:175]
  s_waitcnt vmcnt(12)
  s_barrier
  s_add_u32 m0, s83, 49152
  ds_read_b64_tr_b16 v[96:97], v33 offset:0
  ds_read_b64_tr_b16 v[98:99], v33 offset:1024
  buffer_load_dwordx4 v[208:211], v43, s[76:79], s22 offen sc1
  v_mfma_f32_32x32x16_bf16 v[176:191], v[112:115], a[68:71], v[176:191]
  ds_read_b64_tr_b16 v[100:101], v33 offset:2048
  buffer_load_dwordx4 v12, s[40:43], s7 offen offset:0 lds
  buffer_load_dwordx4 v[212:215], v50, s[76:79], s22 offen sc1
  v_mfma_f32_32x32x16_bf16 v[160:175], v[116:119], a[72:75], v[160:175]
  ds_read_b64_tr_b16 v[102:103], v33 offset:3072
  buffer_load_dwordx4 v13, s[40:43], s7 offen offset:1024 lds
  buffer_load_dwordx4 v[216:219], v43, s[76:79], s23 offen sc1
  v_mfma_f32_32x32x16_bf16 v[176:191], v[116:119], a[76:79], v[176:191]
  ds_read_b64_tr_b16 v[104:105], v33 offset:4096
  ds_read_b64_tr_b16 v[106:107], v33 offset:5120
  buffer_load_dwordx4 v[220:223], v50, s[76:79], s23 offen sc1
  v_mfma_f32_32x32x16_bf16 v[160:175], v[120:123], a[80:83], v[160:175]
  ds_read_b64_tr_b16 v[108:109], v33 offset:6144
  buffer_load_dwordx4 v14, s[40:43], s7 offen offset:2048 lds
  v_mfma_f32_32x32x16_bf16 v[176:191], v[120:123], a[84:87], v[176:191]
  ds_read_b64_tr_b16 v[110:111], v33 offset:7168
  v_mfma_f32_32x32x16_bf16 v[160:175], v[124:127], a[88:91], v[160:175]
  buffer_load_dwordx4 v15, s[40:43], s7 offen offset:3072 lds
  v_mfma_f32_32x32x16_bf16 v[176:191], v[124:127], a[92:95], v[176:191]
  s_waitcnt lgkmcnt(0)
  v_mfma_f32_32x32x16_bf16 v[160:175], v[96:99], a[96:99], v[160:175]
  s_waitcnt vmcnt(16)
  s_barrier
  ds_read_b64_tr_b16 v[112:113], v37 offset:16384
  ds_read_b64_tr_b16 v[114:115], v37 offset:17408
  ds_read_b64_tr_b16 v[116:117], v37 offset:18432
  v_mfma_f32_32x32x16_bf16 v[176:191], v[96:99], a[100:103], v[176:191]
  ds_read_b64_tr_b16 v[118:119], v37 offset:19456
  ds_read_b64_tr_b16 v[120:121], v37 offset:20480
  ds_read_b64_tr_b16 v[122:123], v37 offset:21504
  v_mfma_f32_32x32x16_bf16 v[160:175], v[100:103], a[104:107], v[160:175]
  ds_read_b64_tr_b16 v[124:125], v37 offset:22528
  ds_read_b64_tr_b16 v[126:127], v37 offset:23552
  v_mfma_f32_32x32x16_bf16 v[176:191], v[100:103], a[108:111], v[176:191]
  ds_read_b64_tr_b16 v[192:193], v37 offset:24576
  ds_read_b64_tr_b16 v[194:195], v37 offset:25600
  ds_read_b64_tr_b16 v[196:197], v37 offset:26624
  v_mfma_f32_32x32x16_bf16 v[160:175], v[104:107], a[112:115], v[160:175]
  ds_read_b64_tr_b16 v[198:199], v37 offset:27648
  ds_read_b64_tr_b16 v[200:201], v37 offset:28672
  ds_read_b64_tr_b16 v[202:203], v37 offset:29696
  v_mfma_f32_32x32x16_bf16 v[176:191], v[104:107], a[116:119], v[176:191]
  ds_read_b64_tr_b16 v[204:205], v37 offset:30720
  ds_read_b64_tr_b16 v[206:207], v37 offset:31744
  v_mfma_f32_32x32x16_bf16 v[160:175], v[108:111], a[120:123], v[160:175]
  v_mfma_f32_32x32x16_bf16 v[176:191], v[108:111], a[124:127], v[176:191]
  s_waitcnt lgkmcnt(0)
  v_mfma_f32_32x32x16_bf16 v[128:143], a[0:3], v[112:115], v[128:143]
  s_waitcnt vmcnt(8)
  s_barrier
  ds_read_b64_tr_b16 v[96:97], v36 offset:32768
  ds_read_b64_tr_b16 v[98:99], v36 offset:33792
  ds_read_b64_tr_b16 v[100:101], v36 offset:34816
  s_nop 3
  v_cvt_pk_bf16_f32 v144, v160, v161
  v_cvt_pk_bf16_f32 v145, v162, v163
  v_bfi_b32 v144, s3, -1, v144
  v_cvt_pk_bf16_f32 v146, v164, v165
  v_cvt_pk_bf16_f32 v147, v166, v167
  v_mfma_f32_32x32x16_bf16 v[128:143], a[8:11], v[116:119], v[128:143]
  ds_read_b64_tr_b16 v[102:103], v36 offset:35840
  ds_read_b64_tr_b16 v[104:105], v36 offset:36864
  ds_read_b64_tr_b16 v[106:107], v36 offset:37888
  s_waitcnt vmcnt(2)
L_chk6:
  v_bitop3_b32 v1, v208, v212, v216 bitop3:0x80
  v_bitop3_b32 v1, v1, v220, s3 bitop3:0x80
  v_cmp_gt_u32 vcc, 0x10000, v1
  s_nop 4
  s_cbranch_vccnz L_slow6
L_ok6:
  buffer_store_dwordx4 v[144:147], v43, s[76:79], s22 offen
  v_cvt_pk_bf16_f32 v148, v168, v169
  v_cvt_pk_bf16_f32 v149, v170, v171
  v_mfma_f32_32x32x16_bf16 v[128:143], a[16:19], v[120:123], v[128:143]
  ds_read_b64_tr_b16 v[108:109], v36 offset:38912
  ds_read_b64_tr_b16 v[110:111], v36 offset:39936
  v_bfi_b32 v148, s3, -1, v148
  v_cvt_pk_bf16_f32 v150, v172, v173
  v_cvt_pk_bf16_f32 v151, v174, v175
  buffer_store_dwordx4 v[148:151], v50, s[76:79], s22 offen
  v_cvt_pk_bf16_f32 v152, v176, v177
  v_mfma_f32_32x32x16_bf16 v[128:143], a[24:27], v[124:127], v[128:143]
  ds_read_b64_tr_b16 v[240:241], v36 offset:40960
  ds_read_b64_tr_b16 v[242:243], v36 offset:41984
  ds_read_b64_tr_b16 v[244:245], v36 offset:43008
  v_cvt_pk_bf16_f32 v153, v178, v179
  v_bfi_b32 v152, s3, -1, v152
  v_cvt_pk_bf16_f32 v154, v180, v181
  v_cvt_pk_bf16_f32 v155, v182, v183
  v_mfma_f32_32x32x16_bf16 v[128:143], a[32:35], v[192:195], v[128:143]
  ds_read_b64_tr_b16 v[246:247], v36 offset:44032
  ds_read_b64_tr_b16 v[248:249], v36 offset:45056
  ds_read_b64_tr_b16 v[250:251], v36 offset:46080
  buffer_store_dwordx4 v[152:155], v43, s[76:79], s23 offen
  v_cvt_pk_bf16_f32 v156, v184, v185
  v_cvt_pk_bf16_f32 v157, v186, v187
  v_bfi_b32 v156, s3, -1, v156
  v_cvt_pk_bf16_f32 v158, v188, v189
  v_mfma_f32_32x32x16_bf16 v[128:143], a[40:43], v[196:199], v[128:143]
  ds_read_b64_tr_b16 v[252:253], v36 offset:47104
  ds_read_b64_tr_b16 v[254:255], v36 offset:48128
  v_cvt_pk_bf16_f32 v159, v190, v191
  buffer_store_dwordx4 v[156:159], v50, s[76:79], s23 offen
  v_mfma_f32_32x32x16_bf16 v[128:143], a[48:51], v[200:203], v[128:143]
  v_mfma_f32_32x32x16_bf16 v[128:143], a[56:59], v[204:207], v[128:143]
  s_waitcnt lgkmcnt(0)
  v_mfma_f32_32x32x16_bf16 v[128:143], a[64:67], v[96:99], v[128:143]
  s_waitcnt vmcnt(4)
  s_barrier
  ds_read_b128 v[112:115], v16 offset:49152
  v_mov_b32 v68, 0
  v_mfma_f32_32x32x16_bf16 v[128:143], a[72:75], v[100:103], v[128:143]
  ds_read_b128 v[116:119], v17 offset:49152
  v_mfma_f32_32x32x16_bf16 v[128:143], a[80:83], v[104:107], v[128:143]
  ds_read_b128 v[120:123], v18 offset:49152
  v_mfma_f32_32x32x16_bf16 v[128:143], a[88:91], v[108:111], v[128:143]
  ds_read_b128 v[124:127], v19 offset:49152
  v_mov_b32 v69, 0x3f803f80
  v_mfma_f32_32x32x16_bf16 v[128:143], a[96:99], v[240:243], v[128:143]
  v_mfma_f32_32x32x16_bf16 v[128:143], a[104:107], v[244:247], v[128:143]
  ds_read_b128 v[192:195], v16 offset:57344
  v_mfma_f32_32x32x16_bf16 v[128:143], a[112:115], v[248:251], v[128:143]
  ds_read_b128 v[196:199], v17 offset:57344
  v_mov_b32 v70, 0
  v_mfma_f32_32x32x16_bf16 v[128:143], a[120:123], v[252:255], v[128:143]
  ds_read_b128 v[200:203], v18 offset:57344
  v_mfma_f32_32x32x16_bf16 v[128:143], v[208:211], a[224:227], v[128:143]
  ds_read_b128 v[204:207], v19 offset:57344
  buffer_load_dwordx4 v[224:227], v43, s[76:79], s24 offen sc1
  v_mfma_f32_32x32x16_bf16 v[128:143], v[212:215], a[228:231], v[128:143]
  v_mov_b32 v71, 0
  buffer_load_dwordx4 v[228:231], v50, s[76:79], s24 offen sc1
  v_mfma_f32_32x32x16_bf16 v[128:143], v[216:219], a[224:227], v[128:143]
  buffer_load_dwordx4 v[232:235], v43, s[76:79], s25 offen sc1
  v_mfma_f32_32x32x16_bf16 v[128:143], v[220:223], a[228:231], v[128:143]
  buffer_load_dwordx4 v[236:239], v50, s[76:79], s25 offen sc1
  s_waitcnt lgkmcnt(0)
  v_mfma_f32_32x32x16_bf16 v[128:143], a[128:131], v[112:115], v[128:143]
  v_mfma_f32_32x32x16_bf16 v[128:143], a[136:139], v[116:119], v[128:143]
  v_mfma_f32_32x32x16_bf16 v[128:143], a[144:147], v[120:123], v[128:143]
  v_mfma_f32_32x32x16_bf16 v[128:143], a[152:155], v[124:127], v[128:143]
  v_mfma_f32_32x32x16_bf16 v[160:175], a[252:255], v[68:71], 0
  v_mfma_f32_32x32x16_bf16 v[128:143], a[160:163], v[192:195], v[128:143]
  v_mfma_f32_32x32x16_bf16 v[128:143], a[168:171], v[196:199], v[128:143]
  v_mfma_f32_32x32x16_bf16 v[128:143], a[176:179], v[200:203], v[128:143]
  v_mfma_f32_32x32x16_bf16 v[128:143], a[184:187], v[204:207], v[128:143]
  s_mov_b32 s27, 5376
  s_mov_b32 s28, 10752
  s_mov_b32 s29, 16128
  s_mov_b32 s30, 21504
  s_mov_b32 s31, 26880
  s_waitcnt vmcnt(0)
L_chk7:
  v_mfma_f32_32x32x16_bf16 v[240:255], v[224:227], a[224:227], 0
  v_bitop3_b32 v1, v224, v228, v232 bitop3:0x80
  v_mfma_f32_32x32x16_bf16 v[240:255], v[228:231], a[228:231], v[240:255]
  v_bitop3_b32 v1, v1, v236, s3 bitop3:0x80
  v_mfma_f32_32x32x16_bf16 v[240:255], v[232:235], a[224:227], v[240:255]
  v_cmp_ne_u32 vcc, s3, v1
  v_mul_f32 v96, v128, v160
  v_mul_f32 v97, v129, v161
  v_mul_f32 v98, v130, v162
  v_mul_f32 v99, v131, v163
  v_mul_f32 v100, v132, v164
  v_mul_f32 v101, v133, v165
  v_mfma_f32_32x32x16_bf16 v[240:255], v[236:239], a[228:231], v[240:255]
  s_cbranch_vccnz L_slow7
L_ok7:
  v_mul_f32 v102, v134, v166
  v_mul_f32 v103, v135, v167
  v_mul_f32 v104, v136, v168
  v_mul_f32 v105, v137, v169
  v_mul_f32 v106, v138, v170
  v_mul_f32 v107, v139, v171
  v_mul_f32 v108, v140, v172
  v_mul_f32 v109, v141, v173
  v_mul_f32 v110, v142, v174
  v_mul_f32 v111, v143, v175
  s_nop 0
  v_fmac_f32 v96, v240, v160
  v_fmac_f32 v97, v241, v161
  buffer_store_dword v96, v48, s[76:79], 0 offen offset:0 nt
  v_fmac_f32 v98, v242, v162
  buffer_store_dword v97, v48, s[76:79], 0 offen offset:1792 nt
  v_fmac_f32 v99, v243, v163
  buffer_store_dword v98, v48, s[76:79], 0 offen offset:3584 nt
  v_fmac_f32 v100, v244, v164
  buffer_store_dword v99, v48, s[76:79], s27 offen offset:0 nt
  v_fmac_f32 v101, v245, v165
  buffer_store_dword v100, v48, s[76:79], s27 offen offset:1792 nt
  v_fmac_f32 v102, v246, v166
  buffer_store_dword v101, v48, s[76:79], s27 offen offset:3584 nt
  v_fmac_f32 v103, v247, v167
  buffer_store_dword v102, v48, s[76:79], s28 offen offset:0 nt
  v_fmac_f32 v104, v248, v168
  buffer_store_dword v103, v48, s[76:79], s28 offen offset:1792 nt
  v_fmac_f32 v105, v249, v169
  buffer_store_dword v104, v48, s[76:79], s28 offen offset:3584 nt
  v_fmac_f32 v106, v250, v170
  buffer_store_dword v105, v48, s[76:79], s29 offen offset:0 nt
  v_fmac_f32 v107, v251, v171
  buffer_store_dword v106, v48, s[76:79], s29 offen offset:1792 nt
  v_fmac_f32 v108, v252, v172
  buffer_store_dword v107, v48, s[76:79], s29 offen offset:3584 nt
  v_fmac_f32 v109, v253, v173
  buffer_store_dword v108, v48, s[76:79], s30 offen offset:0 nt
  v_fmac_f32 v110, v254, v174
  buffer_store_dword v109, v48, s[76:79], s30 offen offset:1792 nt
  v_fmac_f32 v111, v255, v175
  buffer_store_dword v110, v48, s[76:79], s30 offen offset:3584 nt
  buffer_store_dword v111, v48, s[76:79], s31 offen offset:0 nt
  s_endpgm
L_helper:
  s_load_dwordx4 s[72:75], s[0:1], 128
  s_memrealtime s[86:87]
  s_add_u32 s21, s20, 128
  s_cmp_eq_u32 s21, 896
  s_cselect_b32 s21, 0, s21
  s_add_u32 s22, s21, 128
  s_cmp_eq_u32 s22, 896
  s_cselect_b32 s22, 0, s22
  s_add_u32 s23, s22, 128
  s_cmp_eq_u32 s23, 896
  s_cselect_b32 s23, 0, s23
  s_add_u32 s24, s23, 128
  s_cmp_eq_u32 s24, 896
  s_cselect_b32 s24, 0, s24
  s_add_u32 s25, s24, 128
  s_cmp_eq_u32 s25, 896
  s_cselect_b32 s25, 0, s25
  s_add_u32 s26, s25, 128
  s_cmp_eq_u32 s26, 896
  s_cselect_b32 s26, 0, s26
  v_and_b32 v82, 31, v0
  v_lshrrev_b32 v83, 5, v0
  v_lshlrev_b32 v69, 4, v81
  v_add_u32 v66, v72, v69
  v_add_u32 v67, 3584, v66
  s_mul_i32 s84, s82, 112
  v_add_u32 v73, s84, v80
  v_mul_u32_u24 v73, 3584, v73
  v_add_u32 v68, v73, v69
  v_mov_b32 v70, 0
  s_mul_i32 s84, s80, 57344
  s_min_u32 s85, s80, 27
  s_lshl_b32 s85, s85, 7
  s_waitcnt lgkmcnt(0)
  s_add_u32 s40, s4, s84
  s_addc_u32 s41, s5, 0
  s_mov_b32 s42, 57344
  s_mov_b32 s43, 0x00020000
  s_add_u32 s52, s56, s85
  s_addc_u32 s53, s57, 0
  s_mov_b32 s54, 1602176
  s_mov_b32 s55, 0x00020000
  s_or_b32 s89, s2, s82
  s_cmp_lg_u32 s89, 0
  s_cbranch_scc1 L_nononce_h
  s_or_b32 s86, s86, 1
  v_mov_b32 v74, 0
  v_mov_b32 v75, s86
  global_store_dword v74, v75, s[72:73] sc1
L_nononce_h:
  s_mov_b64 s[44:45], s[64:65]
  s_mov_b32 s46, 896
  s_mov_b32 s47, 0x00020000
  v_lshl_add_u32 v73, v0, 1, s85
  global_load_ushort v71, v73, s[58:59]
  buffer_load_dwordx4 v[96:99], v66, s[40:43], s20 offen
  buffer_load_dwordx4 v[100:103], v67, s[40:43], s20 offen
  buffer_load_dwordx4 v[224:227], v69, s[44:47], s20 offen
  buffer_load_dwordx4 v[104:107], v66, s[40:43], s21 offen
  buffer_load_dwordx4 v[108:111], v67, s[40:43], s21 offen
  buffer_load_dwordx4 v[228:231], v69, s[44:47], s21 offen
  buffer_load_dwordx4 v[112:115], v66, s[40:43], s22 offen
  buffer_load_dwordx4 v[116:119], v67, s[40:43], s22 offen
  buffer_load_dwordx4 v[232:235], v69, s[44:47], s22 offen
  buffer_load_dwordx4 v[120:123], v66, s[40:43], s23 offen
  buffer_load_dwordx4 v[124:127], v67, s[40:43], s23 offen
  buffer_load_dwordx4 v[236:239], v69, s[44:47], s23 offen
  buffer_load_dwordx4 v[128:131], v66, s[40:43], s24 offen
  buffer_load_dwordx4 v[132:135], v67, s[40:43], s24 offen
  buffer_load_dwordx4 v[240:243], v69, s[44:47], s24 offen
  buffer_load_dwordx4 v[136:139], v66, s[40:43], s25 offen
  buffer_load_dwordx4 v[140:143], v67, s[40:43], s25 offen
  buffer_load_dwordx4 v[244:247], v69, s[44:47], s25 offen
  buffer_load_dwordx4 v[144:147], v66, s[40:43], s26 offen
  buffer_load_dwordx4 v[148:151], v67, s[40:43], s26 offen
  buffer_load_dwordx4 v[248:251], v69, s[44:47], s26 offen
  s_mov_b32 s84, 0
  buffer_load_dwordx4 v[160:163], v68, s[52:55], s84 offen
  s_mov_b32 s84, 28672
  buffer_load_dwordx4 v[164:167], v68, s[52:55], s84 offen
  s_mov_b32 s84, 57344
  buffer_load_dwordx4 v[168:171], v68, s[52:55], s84 offen
  s_mov_b32 s84, 86016
  buffer_load_dwordx4 v[172:175], v68, s[52:55], s84 offen
  s_mov_b32 s84, 114688
  buffer_load_dwordx4 v[176:179], v68, s[52:55], s84 offen
  s_mov_b32 s84, 143360
  buffer_load_dwordx4 v[180:183], v68, s[52:55], s84 offen
  s_mov_b32 s84, 172032
  buffer_load_dwordx4 v[184:187], v68, s[52:55], s84 offen
  s_mul_i32 s84, s80, 114688
  s_add_u32 s76, s66, s84
  s_addc_u32 s77, s67, 0
  s_mov_b32 s78, 114688
  s_mov_b32 s79, 0x00020000
  s_mov_b64 s[56:57], s[60:61]
  s_mov_b32 s58, 1605632
  s_mov_b32 s59, 0x00020000
  s_mov_b64 s[60:61], s[14:15]
  s_mov_b32 s62, 401408
  s_mov_b32 s63, 0x00020000
  s_mov_b64 s[64:65], s[16:17]
  s_mov_b32 s66, 401408
  s_mov_b32 s67, 0x00020000
  s_mov_b64 s[68:69], s[74:75]
  s_mov_b32 s70, 268435456
  s_mov_b32 s71, 0x00020000
  v_mov_b32 v12, 0x3f803f80
  v_mov_b32 v13, 0x3f80
  v_mov_b32 v14, 0x3f800000
  s_mov_b32 s88, 0x20000
  v_mov_b32 v4, 0
  v_mov_b32 v5, 0
  v_mov_b32 v6, 0
  v_mov_b32 v8, 0
  v_mov_b32 v9, 0
  v_mov_b32 v10, 0
  v_mov_b32 v16, 0
  v_mov_b32 v17, 0
  v_mov_b32 v18, 0
  v_mov_b32 v19, 0
  v_mov_b32 v20, 0
  v_mov_b32 v21, 0
  v_mov_b32 v22, 0
  v_mov_b32 v23, 0
  s_waitcnt vmcnt(27)
  v_dot2c_f32_bf16 v4, v96, v12
  v_dot2c_f32_bf16 v5, v96, v96
  s_waitcnt vmcnt(25)
  v_dot2c_f32_bf16 v6, v96, v224
  v_dot2c_f32_bf16 v8, v100, v12
  v_dot2c_f32_bf16 v9, v100, v100
  v_dot2c_f32_bf16 v10, v100, v224
  v_dot2c_f32_bf16 v4, v97, v12
  v_dot2c_f32_bf16 v5, v97, v97
  v_dot2c_f32_bf16 v6, v97, v225
  v_dot2c_f32_bf16 v8, v101, v12
  v_dot2c_f32_bf16 v9, v101, v101
  v_dot2c_f32_bf16 v10, v101, v225
  v_dot2c_f32_bf16 v4, v98, v12
  v_dot2c_f32_bf16 v5, v98, v98
  v_dot2c_f32_bf16 v6, v98, v226
  v_dot2c_f32_bf16 v8, v102, v12
  v_dot2c_f32_bf16 v9, v102, v102
  v_dot2c_f32_bf16 v10, v102, v226
  v_dot2c_f32_bf16 v4, v99, v12
  v_dot2c_f32_bf16 v5, v99, v99
  v_dot2c_f32_bf16 v6, v99, v227
  v_dot2c_f32_bf16 v8, v103, v12
  v_dot2c_f32_bf16 v9, v103, v103
  v_dot2c_f32_bf16 v10, v103, v227
  s_mov_b32 s84, 200704
  buffer_load_dwordx4 v[188:191], v68, s[52:55], s84 offen
  s_waitcnt vmcnt(25)
  v_dot2c_f32_bf16 v4, v104, v12
  v_dot2c_f32_bf16 v5, v104, v104
  s_waitcnt vmcnt(23)
  v_dot2c_f32_bf16 v6, v104, v228
  v_dot2c_f32_bf16 v8, v108, v12
  v_dot2c_f32_bf16 v9, v108, v108
  v_dot2c_f32_bf16 v10, v108, v228
  v_dot2c_f32_bf16 v4, v105, v12
  v_dot2c_f32_bf16 v5, v105, v105
  v_dot2c_f32_bf16 v6, v105, v229
  v_dot2c_f32_bf16 v8, v109, v12
  v_dot2c_f32_bf16 v9, v109, v109
  v_dot2c_f32_bf16 v10, v109, v229
  v_dot2c_f32_bf16 v4, v106, v12
  v_dot2c_f32_bf16 v5, v106, v106
  v_dot2c_f32_bf16 v6, v106, v230
  v_dot2c_f32_bf16 v8, v110, v12
  v_dot2c_f32_bf16 v9, v110, v110
  v_dot2c_f32_bf16 v10, v110, v230
  v_dot2c_f32_bf16 v4, v107, v12
  v_dot2c_f32_bf16 v5, v107, v107
  v_dot2c_f32_bf16 v6, v107, v231
  v_dot2c_f32_bf16 v8, v111, v12
  v_dot2c_f32_bf16 v9, v111, v111
  v_dot2c_f32_bf16 v10, v111, v231
  global_load_dword v79, v70, s[72:73] sc1
  s_mov_b32 s84, 229376
  buffer_load_dwordx4 v[192:195], v68, s[52:55], s84 offen
  s_waitcnt vmcnt(24)
  v_dot2c_f32_bf16 v4, v112, v12
  v_dot2c_f32_bf16 v5, v112, v112
  s_waitcnt vmcnt(22)
  v_dot2c_f32_bf16 v6, v112, v232
  v_dot2c_f32_bf16 v8, v116, v12
  v_dot2c_f32_bf16 v9, v116, v116
  v_dot2c_f32_bf16 v10, v116, v232
  v_dot2c_f32_bf16 v4, v113, v12
  v_dot2c_f32_bf16 v5, v113, v113
  v_dot2c_f32_bf16 v6, v113, v233
  v_dot2c_f32_bf16 v8, v117, v12
  v_dot2c_f32_bf16 v9, v117, v117
  v_dot2c_f32_bf16 v10, v117, v233
  v_dot2c_f32_bf16 v4, v114, v12
  v_dot2c_f32_bf16 v5, v114, v114
  v_dot2c_f32_bf16 v6, v114, v234
  v_dot2c_f32_bf16 v8, v118, v12
  v_dot2c_f32_bf16 v9, v118, v118
  v_dot2c_f32_bf16 v10, v118, v234
  v_dot2c_f32_bf16 v4, v115, v12
  v_dot2c_f32_bf16 v5, v115, v115
  v_dot2c_f32_bf16 v6, v115, v235
  v_dot2c_f32_bf16 v8, v119, v12
  v_dot2c_f32_bf16 v9, v119, v119
  v_dot2c_f32_bf16 v10, v119, v235
  s_mov_b32 s84, 258048
  buffer_load_dwordx4 v[196:199], v68, s[52:55], s84 offen
  s_waitcnt vmcnt(22)
  v_dot2c_f32_bf16 v4, v120, v12
  v_dot2c_f32_bf16 v5, v120, v120
  s_waitcnt vmcnt(20)
  v_dot2c_f32_bf16 v6, v120, v236
  v_dot2c_f32_bf16 v8, v124, v12
  v_dot2c_f32_bf16 v9, v124, v124
  v_dot2c_f32_bf16 v10, v124, v236
  v_dot2c_f32_bf16 v4, v121, v12
  v_dot2c_f32_bf16 v5, v121, v121
  v_dot2c_f32_bf16 v6, v121, v237
  v_dot2c_f32_bf16 v8, v125, v12
  v_dot2c_f32_bf16 v9, v125, v125
  v_dot2c_f32_bf16 v10, v125, v237
  v_dot2c_f32_bf16 v4, v122, v12
  v_dot2c_f32_bf16 v5, v122, v122
  v_dot2c_f32_bf16 v6, v122, v238
  v_dot2c_f32_bf16 v8, v126, v12
  v_dot2c_f32_bf16 v9, v126, v126
  v_dot2c_f32_bf16 v10, v126, v238
  v_dot2c_f32_bf16 v4, v123, v12
  v_dot2c_f32_bf16 v5, v123, v123
  v_dot2c_f32_bf16 v6, v123, v239
  v_dot2c_f32_bf16 v8, v127, v12
  v_dot2c_f32_bf16 v9, v127, v127
  v_dot2c_f32_bf16 v10, v127, v239
  s_mov_b32 s84, 286720
  buffer_load_dwordx4 v[200:203], v68, s[52:55], s84 offen
  s_waitcnt vmcnt(20)
  v_dot2c_f32_bf16 v4, v128, v12
  v_dot2c_f32_bf16 v5, v128, v128
  s_waitcnt vmcnt(18)
  v_dot2c_f32_bf16 v6, v128, v240
  v_dot2c_f32_bf16 v8, v132, v12
  v_dot2c_f32_bf16 v9, v132, v132
  v_dot2c_f32_bf16 v10, v132, v240
  v_dot2c_f32_bf16 v4, v129, v12
  v_dot2c_f32_bf16 v5, v129, v129
  v_dot2c_f32_bf16 v6, v129, v241
  v_dot2c_f32_bf16 v8, v133, v12
  v_dot2c_f32_bf16 v9, v133, v133
  v_dot2c_f32_bf16 v10, v133, v241
  v_dot2c_f32_bf16 v4, v130, v12
  v_dot2c_f32_bf16 v5, v130, v130
  v_dot2c_f32_bf16 v6, v130, v242
  v_dot2c_f32_bf16 v8, v134, v12
  v_dot2c_f32_bf16 v9, v134, v134
  v_dot2c_f32_bf16 v10, v134, v242
  v_dot2c_f32_bf16 v4, v131, v12
  v_dot2c_f32_bf16 v5, v131, v131
  v_dot2c_f32_bf16 v6, v131, v243
  v_dot2c_f32_bf16 v8, v135, v12
  v_dot2c_f32_bf16 v9, v135, v135
  v_dot2c_f32_bf16 v10, v135, v243
  s_mov_b32 s84, 315392
  buffer_load_dwordx4 v[204:207], v68, s[52:55], s84 offen
  s_waitcnt vmcnt(18)
  v_dot2c_f32_bf16 v4, v136, v12
  v_dot2c_f32_bf16 v5, v136, v136
  s_waitcnt vmcnt(16)
  v_dot2c_f32_bf16 v6, v136, v244
  v_dot2c_f32_bf16 v8, v140, v12
  v_dot2c_f32_bf16 v9, v140, v140
  v_dot2c_f32_bf16 v10, v140, v244
  v_dot2c_f32_bf16 v4, v137, v12
  v_dot2c_f32_bf16 v5, v137, v137
  v_dot2c_f32_bf16 v6, v137, v245
  v_dot2c_f32_bf16 v8, v141, v12
  v_dot2c_f32_bf16 v9, v141, v141
  v_dot2c_f32_bf16 v10, v141, v245
  v_dot2c_f32_bf16 v4, v138, v12
  v_dot2c_f32_bf16 v5, v138, v138
  v_dot2c_f32_bf16 v6, v138, v246
  v_dot2c_f32_bf16 v8, v142, v12
  v_dot2c_f32_bf16 v9, v142, v142
  v_dot2c_f32_bf16 v10, v142, v246
  v_dot2c_f32_bf16 v4, v139, v12
  v_dot2c_f32_bf16 v5, v139, v139
  v_dot2c_f32_bf16 v6, v139, v247
  v_dot2c_f32_bf16 v8, v143, v12
  v_dot2c_f32_bf16 v9, v143, v143
  v_dot2c_f32_bf16 v10, v143, v247
  s_mov_b32 s84, 344064
  buffer_load_dwordx4 v[208:211], v68, s[52:55], s84 offen
  s_waitcnt vmcnt(16)
  v_dot2c_f32_bf16 v4, v144, v12
  v_dot2c_f32_bf16 v5, v144, v144
  s_waitcnt vmcnt(14)
  v_dot2c_f32_bf16 v6, v144, v248
  v_dot2c_f32_bf16 v8, v148, v12
  v_dot2c_f32_bf16 v9, v148, v148
  v_dot2c_f32_bf16 v10, v148, v248
  v_dot2c_f32_bf16 v4, v145, v12
  v_dot2c_f32_bf16 v5, v145, v145
  v_dot2c_f32_bf16 v6, v145, v249
  v_dot2c_f32_bf16 v8, v149, v12
  v_dot2c_f32_bf16 v9, v149, v149
  v_dot2c_f32_bf16 v10, v149, v249
  v_dot2c_f32_bf16 v4, v146, v12
  v_dot2c_f32_bf16 v5, v146, v146
  v_dot2c_f32_bf16 v6, v146, v250
  v_dot2c_f32_bf16 v8, v150, v12
  v_dot2c_f32_bf16 v9, v150, v150
  v_dot2c_f32_bf16 v10, v150, v250
  v_dot2c_f32_bf16 v4, v147, v12
  v_dot2c_f32_bf16 v5, v147, v147
  v_dot2c_f32_bf16 v6, v147, v251
  v_dot2c_f32_bf16 v8, v151, v12
  v_dot2c_f32_bf16 v9, v151, v151
  v_dot2c_f32_bf16 v10, v151, v251
  s_mov_b32 s84, 372736
  buffer_load_dwordx4 v[212:215], v68, s[52:55], s84 offen
  v_add_f32_dpp v4, v4, v4 quad_perm:[1,0,3,2] row_mask:0xf bank_mask:0xf
  v_add_f32_dpp v5, v5, v5 quad_perm:[1,0,3,2] row_mask:0xf bank_mask:0xf
  v_add_f32_dpp v6, v6, v6 quad_perm:[1,0,3,2] row_mask:0xf bank_mask:0xf
  v_add_f32_dpp v8, v8, v8 quad_perm:[1,0,3,2] row_mask:0xf bank_mask:0xf
  v_add_f32_dpp v9, v9, v9 quad_perm:[1,0,3,2] row_mask:0xf bank_mask:0xf
  v_add_f32_dpp v10, v10, v10 quad_perm:[1,0,3,2] row_mask:0xf bank_mask:0xf
  v_add_f32_dpp v4, v4, v4 quad_perm:[2,3,0,1] row_mask:0xf bank_mask:0xf
  v_add_f32_dpp v5, v5, v5 quad_perm:[2,3,0,1] row_mask:0xf bank_mask:0xf
  v_add_f32_dpp v6, v6, v6 quad_perm:[2,3,0,1] row_mask:0xf bank_mask:0xf
  v_add_f32_dpp v8, v8, v8 quad_perm:[2,3,0,1] row_mask:0xf bank_mask:0xf
  v_add_f32_dpp v9, v9, v9 quad_perm:[2,3,0,1] row_mask:0xf bank_mask:0xf
  v_add_f32_dpp v10, v10, v10 quad_perm:[2,3,0,1] row_mask:0xf bank_mask:0xf
  v_add_f32_dpp v4, v4, v4 row_half_mirror row_mask:0xf bank_mask:0xf
  v_add_f32_dpp v5, v5, v5 row_half_mirror row_mask:0xf bank_mask:0xf
  v_add_f32_dpp v6, v6, v6 row_half_mirror row_mask:0xf bank_mask:0xf
  v_add_f32_dpp v8, v8, v8 row_half_mirror row_mask:0xf bank_mask:0xf
  v_add_f32_dpp v9, v9, v9 row_half_mirror row_mask:0xf bank_mask:0xf
  v_add_f32_dpp v10, v10, v10 row_half_mirror row_mask:0xf bank_mask:0xf
  v_cmp_lt_u32 vcc, 3, v81
  s_nop 1
  v_cndmask_b32 v4, v4, v8, vcc
  v_cndmask_b32 v5, v5, v9, vcc
  v_cndmask_b32 v6, v6, v10, vcc
  v_lshrrev_b32 v72, 2, v81
  v_lshl_add_u32 v72, v72, 3, v80
  v_lshlrev_b32 v72, 4, v72
  s_lshl_b32 s84, s82, 8
  v_add_u32 v72, s84, v72
  v_and_b32 v73, 3, v81
  v_cmp_eq_u32 vcc, 0, v73
  v_mov_b32 v7, 0x80000000
  s_nop 0
  v_cndmask_b32 v7, v7, v72, vcc
  v_mul_f32 v4, 0x3b124925, v4
  v_mul_f32 v5, 0x3b124925, v5
  v_fma_f32 v5, -v4, v4, v5
  v_max_f32 v5, 0, v5
  v_add_f32 v5, 0x3727c5ac, v5
  v_mul_f32 v6, 0x3fb8aa3b, v6
  v_rsq_f32 v8, v5
  v_min_f32 v6, 0x42660000, v6
  v_max_f32 v6, 0xc2660000, v6
  v_exp_f32 v10, v6
  v_exp_f32 v11, -v6
  v_mul_f32 v9, v5, v8
  v_mul_f32 v29, 0xc0135761, v8
  v_mul_f32 v72, v8, v8
  v_mul_f32 v72, v72, v8
  v_mul_f32 v28, 0xbdd2d3e8, v72
  v_mul_f32 v30, v9, v10
  v_add_f32 v72, 1.0, v11
  v_rcp_f32 v10, v72
  v_mov_b32 v34, 0
  v_mul_f32 v72, 0.5, v9
  v_cvt_pk_bf16_f32 v73, v72, v72
  v_and_b32 v73, 0xffff0000, v73
  v_sub_f32 v72, v72, v73
  v_cvt_pk_bf16_f32 v24, v73, v72
  v_mul_f32 v72, -0.5, v4
  v_cvt_pk_bf16_f32 v73, v72, v72
  v_and_b32 v73, 0xffff0000, v73
  v_sub_f32 v72, v72, v73
  v_cvt_pk_bf16_f32 v25, v73, v72
  v_lshrrev_b32 v26, 16, v73
  v_mul_f32 v72, 0.5, v11
  v_cvt_pk_bf16_f32 v73, v72, v72
  v_and_b32 v73, 0xffff0000, v73
  v_sub_f32 v72, v72, v73
  v_cvt_pk_bf16_f32 v32, v73, v72
  v_mul_f32 v72, 0.5, v10
  v_cvt_pk_bf16_f32 v73, v72, v72
  v_and_b32 v73, 0xffff0000, v73
  v_sub_f32 v72, v72, v73
  v_cvt_pk_bf16_f32 v33, v73, v72
  s_waitcnt vmcnt(6)
L_chk8:
  v_cmp_eq_u32 vcc, 0, v79
  s_nop 4
  s_cbranch_vccnz L_slow8
L_ok8:
  v_mov_b32 v27, v79
  v_mov_b32 v31, v79
  v_mov_b32 v35, v79
  s_lshl_b32 s89, s80, 12
  s_add_u32 s89, s89, 262144
  buffer_store_dwordx4 v[24:27], v7, s[68:71], s89 offen offset:0 sc1
  buffer_store_dwordx4 v[28:31], v7, s[68:71], s89 offen offset:1024 sc1
  buffer_store_dwordx4 v[32:35], v7, s[68:71], s89 offen offset:2048 sc1
  v_dot2c_f32_bf16 v16, v160, v13
  v_dot2c_f32_bf16 v17, v160, v14
  v_dot2c_f32_bf16 v18, v161, v13
  v_dot2c_f32_bf16 v19, v161, v14
  v_dot2c_f32_bf16 v20, v162, v13
  v_dot2c_f32_bf16 v21, v162, v14
  v_dot2c_f32_bf16 v22, v163, v13
  v_dot2c_f32_bf16 v23, v163, v14
  v_dot2c_f32_bf16 v16, v164, v13
  v_dot2c_f32_bf16 v17, v164, v14
  v_dot2c_f32_bf16 v18, v165, v13
  v_dot2c_f32_bf16 v19, v165, v14
  v_dot2c_f32_bf16 v20, v166, v13
  v_dot2c_f32_bf16 v21, v166, v14
  v_dot2c_f32_bf16 v22, v167, v13
  v_dot2c_f32_bf16 v23, v167, v14
  v_dot2c_f32_bf16 v16, v168, v13
  v_dot2c_f32_bf16 v17, v168, v14
  v_dot2c_f32_bf16 v18, v169, v13
  v_dot2c_f32_bf16 v19, v169, v14
  v_dot2c_f32_bf16 v20, v170, v13
  v_dot2c_f32_bf16 v21, v170, v14
  v_dot2c_f32_bf16 v22, v171, v13
  v_dot2c_f32_bf16 v23, v171, v14
  v_dot2c_f32_bf16 v16, v172, v13
  v_dot2c_f32_bf16 v17, v172, v14
  v_dot2c_f32_bf16 v18, v173, v13
  v_dot2c_f32_bf16 v19, v173, v14
  v_dot2c_f32_bf16 v20, v174, v13
  v_dot2c_f32_bf16 v21, v174, v14
  v_dot2c_f32_bf16 v22, v175, v13
  v_dot2c_f32_bf16 v23, v175, v14
  v_dot2c_f32_bf16 v16, v176, v13
  v_dot2c_f32_bf16 v17, v176, v14
  v_dot2c_f32_bf16 v18, v177, v13
  v_dot2c_f32_bf16 v19, v177, v14
  v_dot2c_f32_bf16 v20, v178, v13
  v_dot2c_f32_bf16 v21, v178, v14
  v_dot2c_f32_bf16 v22, v179, v13
  v_dot2c_f32_bf16 v23, v179, v14
  v_dot2c_f32_bf16 v16, v180, v13
  v_dot2c_f32_bf16 v17, v180, v14
  v_dot2c_f32_bf16 v18, v181, v13
  v_dot2c_f32_bf16 v19, v181, v14
  v_dot2c_f32_bf16 v20, v182, v13
  v_dot2c_f32_bf16 v21, v182, v14
  v_dot2c_f32_bf16 v22, v183, v13
  v_dot2c_f32_bf16 v23, v183, v14
  v_dot2c_f32_bf16 v16, v184, v13
  v_dot2c_f32_bf16 v17, v184, v14
  v_dot2c_f32_bf16 v18, v185, v13
  v_dot2c_f32_bf16 v19, v185, v14
  v_dot2c_f32_bf16 v20, v186, v13
  v_dot2c_f32_bf16 v21, v186, v14
  v_dot2c_f32_bf16 v22, v187, v13
  v_dot2c_f32_bf16 v23, v187, v14
  v_dot2c_f32_bf16 v16, v188, v13
  v_dot2c_f32_bf16 v17, v188, v14
  v_dot2c_f32_bf16 v18, v189, v13
  v_dot2c_f32_bf16 v19, v189, v14
  v_dot2c_f32_bf16 v20, v190, v13
  v_dot2c_f32_bf16 v21, v190, v14
  v_dot2c_f32_bf16 v22, v191, v13
  v_dot2c_f32_bf16 v23, v191, v14
  s_waitcnt vmcnt(8)
  v_dot2c_f32_bf16 v16, v192, v13
  v_dot2c_f32_bf16 v17, v192, v14
  v_dot2c_f32_bf16 v18, v193, v13
  v_dot2c_f32_bf16 v19, v193, v14
  v_dot2c_f32_bf16 v20, v194, v13
  v_dot2c_f32_bf16 v21, v194, v14
  v_dot2c_f32_bf16 v22, v195, v13
  v_dot2c_f32_bf16 v23, v195, v14
  s_waitcnt vmcnt(7)
  v_dot2c_f32_bf16 v16, v196, v13
  v_dot2c_f32_bf16 v17, v196, v14
  v_dot2c_f32_bf16 v18, v197, v13
  v_dot2c_f32_bf16 v19, v197, v14
  v_dot2c_f32_bf16 v20, v198, v13
  v_dot2c_f32_bf16 v21, v198, v14
  v_dot2c_f32_bf16 v22, v199, v13
  v_dot2c_f32_bf16 v23, v199, v14
  s_waitcnt vmcnt(6)
  v_dot2c_f32_bf16 v16, v200, v13
  v_dot2c_f32_bf16 v17, v200, v14
  v_dot2c_f32_bf16 v18, v201, v13
  v_dot2c_f32_bf16 v19, v201, v14
  v_dot2c_f32_bf16 v20, v202, v13
  v_dot2c_f32_bf16 v21, v202, v14
  v_dot2c_f32_bf16 v22, v203, v13
  v_dot2c_f32_bf16 v23, v203, v14
  s_waitcnt vmcnt(5)
  v_dot2c_f32_bf16 v16, v204, v13
  v_dot2c_f32_bf16 v17, v204, v14
  v_dot2c_f32_bf16 v18, v205, v13
  v_dot2c_f32_bf16 v19, v205, v14
  v_dot2c_f32_bf16 v20, v206, v13
  v_dot2c_f32_bf16 v21, v206, v14
  v_dot2c_f32_bf16 v22, v207, v13
  v_dot2c_f32_bf16 v23, v207, v14
  s_waitcnt vmcnt(4)
  v_dot2c_f32_bf16 v16, v208, v13
  v_dot2c_f32_bf16 v17, v208, v14
  v_dot2c_f32_bf16 v18, v209, v13
  v_dot2c_f32_bf16 v19, v209, v14
  v_dot2c_f32_bf16 v20, v210, v13
  v_dot2c_f32_bf16 v21, v210, v14
  v_dot2c_f32_bf16 v22, v211, v13
  v_dot2c_f32_bf16 v23, v211, v14
  s_waitcnt vmcnt(3)
  v_dot2c_f32_bf16 v16, v212, v13
  v_dot2c_f32_bf16 v17, v212, v14
  v_dot2c_f32_bf16 v18, v213, v13
  v_dot2c_f32_bf16 v19, v213, v14
  v_dot2c_f32_bf16 v20, v214, v13
  v_dot2c_f32_bf16 v21, v214, v14
  v_dot2c_f32_bf16 v22, v215, v13
  v_dot2c_f32_bf16 v23, v215, v14
  v_permlane32_swap_b32 v16, v20
  v_permlane32_swap_b32 v17, v21
  v_permlane32_swap_b32 v18, v22
  v_permlane32_swap_b32 v19, v23
  v_add_f32 v16, v16, v20
  v_add_f32 v17, v17, v21
  v_add_f32 v18, v18, v22
  v_add_f32 v19, v19, v23
  s_nop 0
  v_permlane16_swap_b32 v16, v18
  v_permlane16_swap_b32 v17, v19
  v_add_f32 v16, v16, v18
  v_add_f32 v17, v17, v19
  v_bfe_u32 v72, v0, 4, 1
  v_lshl_add_u32 v72, v83, 1, v72
  v_lshl_add_u32 v72, v81, 2, v72
  v_lshlrev_b32 v72, 3, v72
  s_lshl_b32 s84, s82, 8
  v_add_u32 v72, s84, v72
  v_add_f32_dpp v16, v16, v16 row_ror:8 row_mask:0xf bank_mask:0xf
  v_add_f32_dpp v17, v17, v17 row_ror:8 row_mask:0xf bank_mask:0xf
  ds_write_b64 v72, v[16:17]
  v_lshlrev_b32 v72, 2, v0
  s_waitcnt lgkmcnt(0)
  s_barrier
  s_cmp_lg_u32 s82, 0
  s_cbranch_scc1 L_hend
  s_cmp_ge_u32 s80, 28
  s_cbranch_scc1 L_hend
  ds_read_b32 v16, v72 offset:0
  ds_read_b32 v17, v72 offset:256
  ds_read_b32 v18, v72 offset:512
  ds_read_b32 v19, v72 offset:768
  v_lshl_or_b32 v24, v71, 16, v71
  v_lshlrev_b32 v7, 4, v0
  s_lshl_b32 s84, s80, 10
  s_add_u32 s84, s84, 393216
  s_waitcnt lgkmcnt(2)
  v_add_f32 v16, v16, v17
  s_waitcnt lgkmcnt(0)
  v_add_f32 v18, v18, v19
  v_add_f32 v16, v16, v18
  v_cvt_pk_bf16_f32 v25, v16, v16
  v_and_b32 v73, 0xffff0000, v25
  v_sub_f32 v73, v16, v73
  v_cvt_pk_bf16_f32 v26, v73, 0
  buffer_store_dwordx4 v[24:27], v7, s[68:71], s84 offen sc1
L_hend:
  s_barrier
  s_lshl_b32 s17, s80, 10
  s_add_u32 s17, s17, 458752
  v_min_u32 v72, 6, v0
  v_lshlrev_b32 v72, 15, v72
  v_readfirstlane_b32 s86, v79
  s_sub_u32 s90, 31, s80
  s_lshl_b32 s90, s90, 10
  s_getreg_b32 s26, hwreg(HW_REG_XCC_ID, 0, 4)
  s_nop 0
  s_lshl1_add_u32 s26, s26, s86
  s_mul_i32 s84, s82, 28672
  v_lshlrev_b32 v73, 4, v0
  v_mov_b32 v28, 0
  v_mov_b32 v29, 0
  v_mov_b32 v30, 0
  v_mov_b32 v31, 0
  s_cmp_lg_u32 s82, 0
  s_cbranch_scc1 L_hp
  buffer_load_dword v24, v72, s[68:71], s90 offen offset:12 sc1
  s_waitcnt vmcnt(0)
L_chk9:
  v_subrev_u32 v74, s86, v24
  v_cmp_lt_u32 vcc, 31, v74
  s_nop 4
  s_cbranch_vccnz L_slow9
L_ok9:
  ds_write_b32 v73, v24 offset:2048
  s_waitcnt lgkmcnt(0)
L_hp:
  s_barrier
  ds_read_b32 v24, v73 offset:2048
  s_mov_b32 s90, s84
  s_lshl2_add_u32 s84, s80, s82
  s_mul_i32 s85, s84, 12544
  v_lshlrev_b32 v73, 7, v0
  v_cmp_gt_u32 vcc, 34, v0
  v_mov_b32 v75, 0x80000000
  buffer_load_dword v1, v73, s[56:59], s85 offen
  v_add_u32 v74, 8192, v73
  v_cndmask_b32 v74, v75, v74, vcc
  buffer_load_dword v1, v74, s[56:59], s85 offen
  s_mul_i32 s85, s84, 3200
  v_cmp_gt_u32 vcc, 25, v0
  s_nop 1
  v_cndmask_b32 v74, v75, v73, vcc
  buffer_load_dword v1, v74, s[60:63], s85 offen
  buffer_load_dword v1, v74, s[64:67], s85 offen
  s_mov_b32 s84, s90
  v_lshlrev_b32 v73, 4, v0
  s_waitcnt lgkmcnt(0)
  v_cmp_ne_u32 vcc, s26, v24
  s_mov_b32 s85, s84
  s_mov_b32 s87, 7
  s_nop 2
  s_cbranch_vccz L_clr0
  s_add_u32 s26, s86, 32
L_clr1:
  buffer_store_dwordx4 v[28:31], v73, s[76:79], s85 offen offset:0 sc1
  buffer_store_dwordx4 v[28:31], v73, s[76:79], s85 offen offset:1024 sc1
  buffer_store_dwordx4 v[28:31], v73, s[76:79], s85 offen offset:2048 sc1
  buffer_store_dwordx4 v[28:31], v73, s[76:79], s85 offen offset:3072 sc1
  s_add_u32 s85, s85, 4096
  s_sub_u32 s87, s87, 1
  s_cmp_lg_u32 s87, 0
  s_cbranch_scc1 L_clr1
  s_branch L_clrd
L_clr0:
  buffer_store_dwordx4 v[28:31], v73, s[76:79], s85 offen offset:0
  buffer_store_dwordx4 v[28:31], v73, s[76:79], s85 offen offset:1024
  buffer_store_dwordx4 v[28:31], v73, s[76:79], s85 offen offset:2048
  buffer_store_dwordx4 v[28:31], v73, s[76:79], s85 offen offset:3072
  s_add_u32 s85, s85, 4096
  s_sub_u32 s87, s87, 1
  s_cmp_lg_u32 s87, 0
  s_cbranch_scc1 L_clr0
L_clrd:
  s_waitcnt vmcnt(0)
  s_barrier
  v_mov_b32 v74, s26
  v_and_b32 v75, 31, v0
  v_lshlrev_b32 v75, 2, v75
  buffer_store_dword v74, v75, s[68:71], s17 offen offset:896 sc1
  v_lshlrev_b32 v2, 7, v0
  v_min_u32 v15, 3968, v2
  s_mul_i32 s85, s82, 28672
  buffer_load_dword v1, v2, s[76:79], s85 offen
  s_add_u32 s85, s85, 8192
  buffer_load_dword v1, v2, s[76:79], s85 offen
  s_add_u32 s85, s85, 8192
  buffer_load_dword v1, v2, s[76:79], s85 offen
  s_add_u32 s85, s85, 8192
  buffer_load_dword v1, v15, s[76:79], s85 offen
  s_add_u32 s85, s85, 8192
  s_waitcnt vmcnt(0)
  s_endpgm
L_far:
  s_waitcnt lgkmcnt(0)
  v_mfma_f32_32x32x16_bf16 v[224:239], v[112:115], a[128:131], v[224:239]
  s_waitcnt vmcnt(8)
  s_barrier
  s_add_u32 m0, s83, 81920
  ds_read_b128 v[96:99], v4 offset:32768
  v_accvgpr_read_b32 v68, a192
  v_accvgpr_read_b32 v69, a193
  v_mfma_f32_32x32x16_bf16 v[240:255], v[112:115], a[132:135], v[240:255]
  ds_read_b128 v[100:103], v5 offset:32768
  buffer_load_dwordx4 v12, s[60:63], s6 offen offset:0 lds
  v_cvt_pk_bf16_f32 v144, v68, v69
  v_accvgpr_read_b32 v70, a194
  v_accvgpr_read_b32 v71, a195
  v_cvt_pk_bf16_f32 v145, v70, v71
  v_bfi_b32 v144, s3, 1, v144
  v_accvgpr_read_b32 v80, a196
  v_accvgpr_read_b32 v81, a197
  v_cvt_pk_bf16_f32 v146, v80, v81
  v_mfma_f32_32x32x16_bf16 v[224:239], v[116:119], a[136:139], v[224:239]
  buffer_load_dwordx4 v13, s[60:63], s6 offen offset:1024 lds
  v_accvgpr_read_b32 v82, a198
  v_accvgpr_read_b32 v83, a199
  v_cvt_pk_bf16_f32 v147, v82, v83
  buffer_store_dwordx4 v[144:147], v43, s[76:79], s10 offen sc1
  v_accvgpr_read_b32 v68, a200
  v_accvgpr_read_b32 v69, a201
  v_cvt_pk_bf16_f32 v148, v68, v69
  v_accvgpr_read_b32 v70, a202
  v_mfma_f32_32x32x16_bf16 v[240:255], v[116:119], a[140:143], v[240:255]
  ds_read_b128 v[104:107], v6 offset:32768
  v_accvgpr_read_b32 v71, a203
  v_cvt_pk_bf16_f32 v149, v70, v71
  v_bfi_b32 v148, s3, 1, v148
  v_accvgpr_read_b32 v80, a204
  v_accvgpr_read_b32 v81, a205
  v_cvt_pk_bf16_f32 v150, v80, v81
  v_accvgpr_read_b32 v82, a206
  v_mfma_f32_32x32x16_bf16 v[224:239], v[120:123], a[144:147], v[224:239]
  ds_read_b128 v[108:111], v7 offset:32768
  buffer_load_dwordx4 v14, s[60:63], s6 offen offset:2048 lds
  v_accvgpr_read_b32 v83, a207
  v_cvt_pk_bf16_f32 v151, v82, v83
  buffer_store_dwordx4 v[148:151], v50, s[76:79], s10 offen sc1
  v_accvgpr_read_b32 v68, a208
  v_accvgpr_read_b32 v69, a209
  v_cvt_pk_bf16_f32 v152, v68, v69
  v_accvgpr_read_b32 v70, a210
  v_accvgpr_read_b32 v71, a211
  v_mfma_f32_32x32x16_bf16 v[240:255], v[120:123], a[148:151], v[240:255]
  v_cvt_pk_bf16_f32 v153, v70, v71
  v_bfi_b32 v152, s3, 1, v152
  v_accvgpr_read_b32 v80, a212
  v_accvgpr_read_b32 v81, a213
  v_cvt_pk_bf16_f32 v154, v80, v81
  v_accvgpr_read_b32 v82, a214
  v_accvgpr_read_b32 v83, a215
  v_cvt_pk_bf16_f32 v155, v82, v83
  v_mfma_f32_32x32x16_bf16 v[224:239], v[124:127], a[152:155], v[224:239]
  buffer_load_dwordx4 v15, s[60:63], s6 offen offset:3072 lds
  buffer_store_dwordx4 v[152:155], v43, s[76:79], s11 offen sc1
  v_accvgpr_read_b32 v68, a216
  v_accvgpr_read_b32 v69, a217
  v_cvt_pk_bf16_f32 v156, v68, v69
  v_accvgpr_read_b32 v70, a218
  v_accvgpr_read_b32 v71, a219
  v_cvt_pk_bf16_f32 v157, v70, v71
  v_bfi_b32 v156, s3, 1, v156
  v_mfma_f32_32x32x16_bf16 v[240:255], v[124:127], a[156:159], v[240:255]
  v_accvgpr_read_b32 v80, a220
  v_accvgpr_read_b32 v81, a221
  v_cvt_pk_bf16_f32 v158, v80, v81
  v_accvgpr_read_b32 v82, a222
  v_accvgpr_read_b32 v83, a223
  v_cvt_pk_bf16_f32 v159, v82, v83
  buffer_store_dwordx4 v[156:159], v50, s[76:79], s11 offen sc1
  s_waitcnt lgkmcnt(0)
  v_mfma_f32_32x32x16_bf16 v[224:239], v[96:99], a[160:163], v[224:239]
  s_waitcnt vmcnt(12)
  s_barrier
  s_add_u32 m0, s83, 32768
  ds_read_b64_tr_b16 v[112:113], v32 offset:49152
  ds_read_b64_tr_b16 v[114:115], v32 offset:50176
  s_mul_i32 s45, s49, 37
  s_lshr_b32 s45, s45, 8
  v_mfma_f32_32x32x16_bf16 v[240:255], v[96:99], a[164:167], v[240:255]
  ds_read_b64_tr_b16 v[116:117], v32 offset:51200
  buffer_load_dwordx4 v12, s[64:67], s6 offen offset:0 lds
  s_mul_i32 s45, s45, 7
  v_mfma_f32_32x32x16_bf16 v[224:239], v[100:103], a[168:171], v[224:239]
  ds_read_b64_tr_b16 v[118:119], v32 offset:52224
  buffer_load_dwordx4 v13, s[64:67], s6 offen offset:1024 lds
  s_sub_u32 s49, s49, s45
  s_lshl_b32 s49, s49, 8
  v_mfma_f32_32x32x16_bf16 v[240:255], v[100:103], a[172:175], v[240:255]
  ds_read_b64_tr_b16 v[120:121], v32 offset:53248
  ds_read_b64_tr_b16 v[122:123], v32 offset:54272
  s_sub_u32 s23, s49, s48
  v_mfma_f32_32x32x16_bf16 v[224:239], v[104:107], a[176:179], v[224:239]
  ds_read_b64_tr_b16 v[124:125], v32 offset:55296
  buffer_load_dwordx4 v14, s[64:67], s6 offen offset:2048 lds
  s_add_u32 s23, s23, 57344
  s_add_u32 s49, s49, s48
  v_mfma_f32_32x32x16_bf16 v[240:255], v[104:107], a[180:183], v[240:255]
  ds_read_b64_tr_b16 v[126:127], v32 offset:56320
  s_lshl1_add_u32 s22, s48, s49
  v_mfma_f32_32x32x16_bf16 v[224:239], v[108:111], a[184:187], v[224:239]
  buffer_load_dwordx4 v15, s[64:67], s6 offen offset:3072 lds
  s_lshl_b32 s49, s81, 8
  s_lshl1_add_u32 s24, s48, s49
  v_mfma_f32_32x32x16_bf16 v[240:255], v[108:111], a[188:191], v[240:255]
  s_add_u32 s25, s24, 28672
  s_waitcnt lgkmcnt(0)
  v_mfma_f32_32x32x16_bf16 v[224:239], v[112:115], a[64:67], v[224:239]
  s_waitcnt vmcnt(12)
  s_barrier
  s_add_u32 m0, s83, 49152
  ds_read_b64_tr_b16 v[96:97], v33 offset:0
  ds_read_b64_tr_b16 v[98:99], v33 offset:1024
  v_mfma_f32_32x32x16_bf16 v[240:255], v[112:115], a[68:71], v[240:255]
  ds_read_b64_tr_b16 v[100:101], v33 offset:2048
  buffer_load_dwordx4 v8, s[56:59], s39 offen offset:0 lds
  v_mfma_f32_32x32x16_bf16 v[224:239], v[116:119], a[72:75], v[224:239]
  ds_read_b64_tr_b16 v[102:103], v33 offset:3072
  buffer_load_dwordx4 v9, s[56:59], s39 offen offset:1024 lds
  buffer_load_dwordx4 v[192:195], v43, s[76:79], s20 offen sc1
  v_mfma_f32_32x32x16_bf16 v[240:255], v[116:119], a[76:79], v[240:255]
  ds_read_b64_tr_b16 v[104:105], v33 offset:4096
  ds_read_b64_tr_b16 v[106:107], v33 offset:5120
  buffer_load_dwordx4 v[196:199], v50, s[76:79], s20 offen sc1
  v_mfma_f32_32x32x16_bf16 v[224:239], v[120:123], a[80:83], v[224:239]
  ds_read_b64_tr_b16 v[108:109], v33 offset:6144
  buffer_load_dwordx4 v10, s[56:59], s39 offen offset:2048 lds
  buffer_load_dwordx4 v[200:203], v43, s[76:79], s21 offen sc1
  v_mfma_f32_32x32x16_bf16 v[240:255], v[120:123], a[84:87], v[240:255]
  ds_read_b64_tr_b16 v[110:111], v33 offset:7168
  buffer_load_dwordx4 v[204:207], v50, s[76:79], s21 offen sc1
  v_mfma_f32_32x32x16_bf16 v[224:239], v[124:127], a[88:91], v[224:239]
  buffer_load_dwordx4 v11, s[56:59], s39 offen offset:3072 lds
  v_mfma_f32_32x32x16_bf16 v[240:255], v[124:127], a[92:95], v[240:255]
  s_waitcnt lgkmcnt(0)
  v_mfma_f32_32x32x16_bf16 v[224:239], v[96:99], a[96:99], v[224:239]
  s_waitcnt vmcnt(14)
  s_barrier
  s_add_u32 m0, s83, 65536
  s_add_u32 s84, s39, 14336
  ds_read_b128 v[112:115], v20 offset:16384
  v_mfma_f32_32x32x16_bf16 v[240:255], v[96:99], a[100:103], v[240:255]
  ds_read_b128 v[116:119], v21 offset:16384
  buffer_load_dwordx4 v8, s[56:59], s84 offen offset:0 lds
  v_mfma_f32_32x32x16_bf16 v[224:239], v[100:103], a[104:107], v[224:239]
  buffer_load_dwordx4 v9, s[56:59], s84 offen offset:1024 lds
  v_mfma_f32_32x32x16_bf16 v[240:255], v[100:103], a[108:111], v[240:255]
  ds_read_b128 v[120:123], v22 offset:16384
  v_mfma_f32_32x32x16_bf16 v[224:239], v[104:107], a[112:115], v[224:239]
  ds_read_b128 v[124:127], v23 offset:16384
  buffer_load_dwordx4 v10, s[56:59], s84 offen offset:2048 lds
  v_mfma_f32_32x32x16_bf16 v[240:255], v[104:107], a[116:119], v[240:255]
  v_mfma_f32_32x32x16_bf16 v[224:239], v[108:111], a[120:123], v[224:239]
  buffer_load_dwordx4 v11, s[56:59], s84 offen offset:3072 lds
  v_mfma_f32_32x32x16_bf16 v[240:255], v[108:111], a[124:127], v[240:255]
  s_waitcnt lgkmcnt(0)
  v_mfma_f32_32x32x16_bf16 v[160:175], v[112:115], a[128:131], v[160:175]
  s_waitcnt vmcnt(12)
  s_barrier
  s_add_u32 m0, s83, 81920
  ds_read_b128 v[96:99], v4 offset:32768
  s_nop 3
  v_cvt_pk_bf16_f32 v144, v224, v225
  v_mfma_f32_32x32x16_bf16 v[176:191], v[112:115], a[132:135], v[176:191]
  ds_read_b128 v[100:103], v5 offset:32768
  buffer_load_dwordx4 v8, s[56:59], s8 offen offset:0 lds
  v_cvt_pk_bf16_f32 v145, v226, v227
  v_bfi_b32 v144, s3, -2, v144
  v_cvt_pk_bf16_f32 v146, v228, v229
  v_cvt_pk_bf16_f32 v147, v230, v231
  v_mfma_f32_32x32x16_bf16 v[160:175], v[116:119], a[136:139], v[160:175]
  buffer_load_dwordx4 v9, s[56:59], s8 offen offset:1024 lds
  v_cvt_pk_bf16_f32 v148, v232, v233
  v_cvt_pk_bf16_f32 v149, v234, v235
  v_bfi_b32 v148, s3, -2, v148
  v_mfma_f32_32x32x16_bf16 v[176:191], v[116:119], a[140:143], v[176:191]
  ds_read_b128 v[104:107], v6 offset:32768
  v_cvt_pk_bf16_f32 v150, v236, v237
  v_cvt_pk_bf16_f32 v151, v238, v239
  v_cvt_pk_bf16_f32 v152, v240, v241
  v_cvt_pk_bf16_f32 v153, v242, v243
  v_mfma_f32_32x32x16_bf16 v[160:175], v[120:123], a[144:147], v[160:175]
  ds_read_b128 v[108:111], v7 offset:32768
  buffer_load_dwordx4 v10, s[56:59], s8 offen offset:2048 lds
  v_bfi_b32 v152, s3, -2, v152
  v_cvt_pk_bf16_f32 v154, v244, v245
  v_cvt_pk_bf16_f32 v155, v246, v247
  v_mfma_f32_32x32x16_bf16 v[176:191], v[120:123], a[148:151], v[176:191]
  v_cvt_pk_bf16_f32 v156, v248, v249
  v_cvt_pk_bf16_f32 v157, v250, v251
  v_bfi_b32 v156, s3, -2, v156
  v_cvt_pk_bf16_f32 v158, v252, v253
  v_mfma_f32_32x32x16_bf16 v[160:175], v[124:127], a[152:155], v[160:175]
  buffer_load_dwordx4 v11, s[56:59], s8 offen offset:3072 lds
  v_cvt_pk_bf16_f32 v159, v254, v255
  s_waitcnt vmcnt(9)
L_chk10:
  v_bitop3_b32 v1, v192, v196, v200 bitop3:0x80
  v_bitop3_b32 v1, v1, v204, s3 bitop3:0x80
  v_cmp_ne_u32 vcc, 1, v1
  s_nop 4
  s_cbranch_vccnz L_slow10
L_ok10:
  buffer_store_dwordx4 v[144:147], v43, s[76:79], s20 offen sc1
  v_mfma_f32_32x32x16_bf16 v[176:191], v[124:127], a[156:159], v[176:191]
  buffer_store_dwordx4 v[148:151], v50, s[76:79], s20 offen sc1
  buffer_store_dwordx4 v[152:155], v43, s[76:79], s21 offen sc1
  buffer_store_dwordx4 v[156:159], v50, s[76:79], s21 offen sc1
  s_waitcnt lgkmcnt(0)
  v_mfma_f32_32x32x16_bf16 v[160:175], v[96:99], a[160:163], v[160:175]
  s_waitcnt vmcnt(12)
  s_barrier
  s_add_u32 m0, s83, 32768
  ds_read_b64_tr_b16 v[112:113], v32 offset:49152
  v_mfma_f32_32x32x16_bf16 v[176:191], v[96:99], a[164:167], v[176:191]
  ds_read_b64_tr_b16 v[114:115], v32 offset:50176
  buffer_load_dwordx4 v8, s[56:59], s9 offen offset:0 lds
  v_mfma_f32_32x32x16_bf16 v[160:175], v[100:103], a[168:171], v[160:175]
  ds_read_b64_tr_b16 v[116:117], v32 offset:51200
  v_mfma_f32_32x32x16_bf16 v[176:191], v[100:103], a[172:175], v[176:191]
  ds_read_b64_tr_b16 v[118:119], v32 offset:52224
  buffer_load_dwordx4 v9, s[56:59], s9 offen offset:1024 lds
  v_mfma_f32_32x32x16_bf16 v[160:175], v[104:107], a[176:179], v[160:175]
  v_mfma_f32_32x32x16_bf16 v[176:191], v[104:107], a[180:183], v[176:191]
  ds_read_b64_tr_b16 v[120:121], v32 offset:53248
  v_mfma_f32_32x32x16_bf16 v[160:175], v[108:111], a[184:187], v[160:175]
  ds_read_b64_tr_b16 v[122:123], v32 offset:54272
  buffer_load_dwordx4 v10, s[56:59], s9 offen offset:2048 lds
  v_mfma_f32_32x32x16_bf16 v[176:191], v[108:111], a[188:191], v[176:191]
  ds_read_b64_tr_b16 v[124:125], v32 offset:55296
  v_mfma_f32_32x32x16_bf16 v[128:143], v[192:195], a[224:227], v[128:143]
  ds_read_b64_tr_b16 v[126:127], v32 offset:56320
  v_mfma_f32_32x32x16_bf16 v[128:143], v[196:199], a[228:231], v[128:143]
  buffer_load_dwordx4 v11, s[56:59], s9 offen offset:3072 lds
  v_mfma_f32_32x32x16_bf16 v[128:143], v[200:203], a[224:227], v[128:143]
  v_mfma_f32_32x32x16_bf16 v[128:143], v[204:207], a[228:231], v[128:143]
  s_waitcnt lgkmcnt(0)
  v_mfma_f32_32x32x16_bf16 v[160:175], v[112:115], a[64:67], v[160:175]
  s_waitcnt vmcnt(12)
  s_barrier
  s_add_u32 m0, s83, 49152
  ds_read_b64_tr_b16 v[96:97], v33 offset:0
  ds_read_b64_tr_b16 v[98:99], v33 offset:1024
  buffer_load_dwordx4 v[208:211], v43, s[76:79], s22 offen sc1
  v_mfma_f32_32x32x16_bf16 v[176:191], v[112:115], a[68:71], v[176:191]
  ds_read_b64_tr_b16 v[100:101], v33 offset:2048
  buffer_load_dwordx4 v12, s[40:43], s7 offen offset:0 lds
  buffer_load_dwordx4 v[212:215], v50, s[76:79], s22 offen sc1
  v_mfma_f32_32x32x16_bf16 v[160:175], v[116:119], a[72:75], v[160:175]
  ds_read_b64_tr_b16 v[102:103], v33 offset:3072
  buffer_load_dwordx4 v13, s[40:43], s7 offen offset:1024 lds
  buffer_load_dwordx4 v[216:219], v43, s[76:79], s23 offen sc1
  v_mfma_f32_32x32x16_bf16 v[176:191], v[116:119], a[76:79], v[176:191]
  ds_read_b64_tr_b16 v[104:105], v33 offset:4096
  ds_read_b64_tr_b16 v[106:107], v33 offset:5120
  buffer_load_dwordx4 v[220:223], v50, s[76:79], s23 offen sc1
  v_mfma_f32_32x32x16_bf16 v[160:175], v[120:123], a[80:83], v[160:175]
  ds_read_b64_tr_b16 v[108:109], v33 offset:6144
  buffer_load_dwordx4 v14, s[40:43], s7 offen offset:2048 lds
  v_mfma_f32_32x32x16_bf16 v[176:191], v[120:123], a[84:87], v[176:191]
  ds_read_b64_tr_b16 v[110:111], v33 offset:7168
  v_mfma_f32_32x32x16_bf16 v[160:175], v[124:127], a[88:91], v[160:175]
  buffer_load_dwordx4 v15, s[40:43], s7 offen offset:3072 lds
  v_mfma_f32_32x32x16_bf16 v[176:191], v[124:127], a[92:95], v[176:191]
  s_waitcnt lgkmcnt(0)
  v_mfma_f32_32x32x16_bf16 v[160:175], v[96:99], a[96:99], v[160:175]
  s_waitcnt vmcnt(16)
  s_barrier
  ds_read_b64_tr_b16 v[112:113], v37 offset:16384
  ds_read_b64_tr_b16 v[114:115], v37 offset:17408
  ds_read_b64_tr_b16 v[116:117], v37 offset:18432
  v_mfma_f32_32x32x16_bf16 v[176:191], v[96:99], a[100:103], v[176:191]
  ds_read_b64_tr_b16 v[118:119], v37 offset:19456
  ds_read_b64_tr_b16 v[120:121], v37 offset:20480
  ds_read_b64_tr_b16 v[122:123], v37 offset:21504
  v_mfma_f32_32x32x16_bf16 v[160:175], v[100:103], a[104:107], v[160:175]
  ds_read_b64_tr_b16 v[124:125], v37 offset:22528
  ds_read_b64_tr_b16 v[126:127], v37 offset:23552
  v_mfma_f32_32x32x16_bf16 v[176:191], v[100:103], a[108:111], v[176:191]
  ds_read_b64_tr_b16 v[192:193], v37 offset:24576
  ds_read_b64_tr_b16 v[194:195], v37 offset:25600
  ds_read_b64_tr_b16 v[196:197], v37 offset:26624
  v_mfma_f32_32x32x16_bf16 v[160:175], v[104:107], a[112:115], v[160:175]
  ds_read_b64_tr_b16 v[198:199], v37 offset:27648
  ds_read_b64_tr_b16 v[200:201], v37 offset:28672
  ds_read_b64_tr_b16 v[202:203], v37 offset:29696
  v_mfma_f32_32x32x16_bf16 v[176:191], v[104:107], a[116:119], v[176:191]
  ds_read_b64_tr_b16 v[204:205], v37 offset:30720
  ds_read_b64_tr_b16 v[206:207], v37 offset:31744
  v_mfma_f32_32x32x16_bf16 v[160:175], v[108:111], a[120:123], v[160:175]
  v_mfma_f32_32x32x16_bf16 v[176:191], v[108:111], a[124:127], v[176:191]
  s_waitcnt lgkmcnt(0)
  v_mfma_f32_32x32x16_bf16 v[128:143], a[0:3], v[112:115], v[128:143]
  s_waitcnt vmcnt(8)
  s_barrier
  ds_read_b64_tr_b16 v[96:97], v36 offset:32768
  ds_read_b64_tr_b16 v[98:99], v36 offset:33792
  ds_read_b64_tr_b16 v[100:101], v36 offset:34816
  s_nop 3
  v_cvt_pk_bf16_f32 v144, v160, v161
  v_cvt_pk_bf16_f32 v145, v162, v163
  v_bfi_b32 v144, s3, -1, v144
  v_cvt_pk_bf16_f32 v146, v164, v165
  v_cvt_pk_bf16_f32 v147, v166, v167
  v_mfma_f32_32x32x16_bf16 v[128:143], a[8:11], v[116:119], v[128:143]
  ds_read_b64_tr_b16 v[102:103], v36 offset:35840
  ds_read_b64_tr_b16 v[104:105], v36 offset:36864
  ds_read_b64_tr_b16 v[106:107], v36 offset:37888
  s_waitcnt vmcnt(2)
L_chk11:
  v_bitop3_b32 v1, v208, v212, v216 bitop3:0x80
  v_bitop3_b32 v1, v1, v220, s3 bitop3:0x80
  v_cmp_gt_u32 vcc, 0x10000, v1
  s_nop 4
  s_cbranch_vccnz L_slow11
L_ok11:
  buffer_store_dwordx4 v[144:147], v43, s[76:79], s22 offen sc1
  v_cvt_pk_bf16_f32 v148, v168, v169
  v_cvt_pk_bf16_f32 v149, v170, v171
  v_mfma_f32_32x32x16_bf16 v[128:143], a[16:19], v[120:123], v[128:143]
  ds_read_b64_tr_b16 v[108:109], v36 offset:38912
  ds_read_b64_tr_b16 v[110:111], v36 offset:39936
  v_bfi_b32 v148, s3, -1, v148
  v_cvt_pk_bf16_f32 v150, v172, v173
  v_cvt_pk_bf16_f32 v151, v174, v175
  buffer_store_dwordx4 v[148:151], v50, s[76:79], s22 offen sc1
  v_cvt_pk_bf16_f32 v152, v176, v177
  v_mfma_f32_32x32x16_bf16 v[128:143], a[24:27], v[124:127], v[128:143]
  ds_read_b64_tr_b16 v[240:241], v36 offset:40960
  ds_read_b64_tr_b16 v[242:243], v36 offset:41984
  ds_read_b64_tr_b16 v[244:245], v36 offset:43008
  v_cvt_pk_bf16_f32 v153, v178, v179
  v_bfi_b32 v152, s3, -1, v152
  v_cvt_pk_bf16_f32 v154, v180, v181
  v_cvt_pk_bf16_f32 v155, v182, v183
  v_mfma_f32_32x32x16_bf16 v[128:143], a[32:35], v[192:195], v[128:143]
  ds_read_b64_tr_b16 v[246:247], v36 offset:44032
  ds_read_b64_tr_b16 v[248:249], v36 offset:45056
  ds_read_b64_tr_b16 v[250:251], v36 offset:46080
  buffer_store_dwordx4 v[152:155], v43, s[76:79], s23 offen sc1
  v_cvt_pk_bf16_f32 v156, v184, v185
  v_cvt_pk_bf16_f32 v157, v186, v187
  v_bfi_b32 v156, s3, -1, v156
  v_cvt_pk_bf16_f32 v158, v188, v189
  v_mfma_f32_32x32x16_bf16 v[128:143], a[40:43], v[196:199], v[128:143]
  ds_read_b64_tr_b16 v[252:253], v36 offset:47104
  ds_read_b64_tr_b16 v[254:255], v36 offset:48128
  v_cvt_pk_bf16_f32 v159, v190, v191
  buffer_store_dwordx4 v[156:159], v50, s[76:79], s23 offen sc1
  v_mfma_f32_32x32x16_bf16 v[128:143], a[48:51], v[200:203], v[128:143]
  v_mfma_f32_32x32x16_bf16 v[128:143], a[56:59], v[204:207], v[128:143]
  s_waitcnt lgkmcnt(0)
  v_mfma_f32_32x32x16_bf16 v[128:143], a[64:67], v[96:99], v[128:143]
  s_waitcnt vmcnt(4)
  s_barrier
  ds_read_b128 v[112:115], v16 offset:49152
  v_mov_b32 v68, 0
  v_mfma_f32_32x32x16_bf16 v[128:143], a[72:75], v[100:103], v[128:143]
  ds_read_b128 v[116:119], v17 offset:49152
  v_mfma_f32_32x32x16_bf16 v[128:143], a[80:83], v[104:107], v[128:143]
  ds_read_b128 v[120:123], v18 offset:49152
  v_mfma_f32_32x32x16_bf16 v[128:143], a[88:91], v[108:111], v[128:143]
  ds_read_b128 v[124:127], v19 offset:49152
  v_mov_b32 v69, 0x3f803f80
  v_mfma_f32_32x32x16_bf16 v[128:143], a[96:99], v[240:243], v[128:143]
  v_mfma_f32_32x32x16_bf16 v[128:143], a[104:107], v[244:247], v[128:143]
  ds_read_b128 v[192:195], v16 offset:57344
  v_mfma_f32_32x32x16_bf16 v[128:143], a[112:115], v[248:251], v[128:143]
  ds_read_b128 v[196:199], v17 offset:57344
  v_mov_b32 v70, 0
  v_mfma_f32_32x32x16_bf16 v[128:143], a[120:123], v[252:255], v[128:143]
  ds_read_b128 v[200:203], v18 offset:57344
  v_mfma_f32_32x32x16_bf16 v[128:143], v[208:211], a[224:227], v[128:143]
  ds_read_b128 v[204:207], v19 offset:57344
  buffer_load_dwordx4 v[224:227], v43, s[76:79], s24 offen sc1
  v_mfma_f32_32x32x16_bf16 v[128:143], v[212:215], a[228:231], v[128:143]
  v_mov_b32 v71, 0
  buffer_load_dwordx4 v[228:231], v50, s[76:79], s24 offen sc1
  v_mfma_f32_32x32x16_bf16 v[128:143], v[216:219], a[224:227], v[128:143]
  buffer_load_dwordx4 v[232:235], v43, s[76:79], s25 offen sc1
  v_mfma_f32_32x32x16_bf16 v[128:143], v[220:223], a[228:231], v[128:143]
  buffer_load_dwordx4 v[236:239], v50, s[76:79], s25 offen sc1
  s_waitcnt lgkmcnt(0)
  v_mfma_f32_32x32x16_bf16 v[128:143], a[128:131], v[112:115], v[128:143]
  v_mfma_f32_32x32x16_bf16 v[128:143], a[136:139], v[116:119], v[128:143]
  v_mfma_f32_32x32x16_bf16 v[128:143], a[144:147], v[120:123], v[128:143]
  v_mfma_f32_32x32x16_bf16 v[128:143], a[152:155], v[124:127], v[128:143]
  v_mfma_f32_32x32x16_bf16 v[160:175], a[252:255], v[68:71], 0
  v_mfma_f32_32x32x16_bf16 v[128:143], a[160:163], v[192:195], v[128:143]
  v_mfma_f32_32x32x16_bf16 v[128:143], a[168:171], v[196:199], v[128:143]
  v_mfma_f32_32x32x16_bf16 v[128:143], a[176:179], v[200:203], v[128:143]
  v_mfma_f32_32x32x16_bf16 v[128:143], a[184:187], v[204:207], v[128:143]
  s_mov_b32 s27, 5376
  s_mov_b32 s28, 10752
  s_mov_b32 s29, 16128
  s_mov_b32 s30, 21504
  s_mov_b32 s31, 26880
  s_waitcnt vmcnt(0)
L_chk12:
  v_mfma_f32_32x32x16_bf16 v[240:255], v[224:227], a[224:227], 0
  v_bitop3_b32 v1, v224, v228, v232 bitop3:0x80
  v_mfma_f32_32x32x16_bf16 v[240:255], v[228:231], a[228:231], v[240:255]
  v_bitop3_b32 v1, v1, v236, s3 bitop3:0x80
  v_mfma_f32_32x32x16_bf16 v[240:255], v[232:235], a[224:227], v[240:255]
  v_cmp_ne_u32 vcc, s3, v1
  v_mul_f32 v96, v128, v160
  v_mul_f32 v97, v129, v161
  v_mul_f32 v98, v130, v162
  v_mul_f32 v99, v131, v163
  v_mul_f32 v100, v132, v164
  v_mul_f32 v101, v133, v165
  v_mfma_f32_32x32x16_bf16 v[240:255], v[236:239], a[228:231], v[240:255]
  s_cbranch_vccnz L_slow12
L_ok12:
  v_mul_f32 v102, v134, v166
  v_mul_f32 v103, v135, v167
  v_mul_f32 v104, v136, v168
  v_mul_f32 v105, v137, v169
  v_mul_f32 v106, v138, v170
  v_mul_f32 v107, v139, v171
  v_mul_f32 v108, v140, v172
  v_mul_f32 v109, v141, v173
  v_mul_f32 v110, v142, v174
  v_mul_f32 v111, v143, v175
  s_nop 0
  v_fmac_f32 v96, v240, v160
  v_fmac_f32 v97, v241, v161
  buffer_store_dword v96, v48, s[76:79], 0 offen offset:0 sc1
  v_fmac_f32 v98, v242, v162
  buffer_store_dword v97, v48, s[76:79], 0 offen offset:1792 sc1
  v_fmac_f32 v99, v243, v163
  buffer_store_dword v98, v48, s[76:79], 0 offen offset:3584 sc1
  v_fmac_f32 v100, v244, v164
  buffer_store_dword v99, v48, s[76:79], s27 offen offset:0 sc1
  v_fmac_f32 v101, v245, v165
  buffer_store_dword v100, v48, s[76:79], s27 offen offset:1792 sc1
  v_fmac_f32 v102, v246, v166
  buffer_store_dword v101, v48, s[76:79], s27 offen offset:3584 sc1
  v_fmac_f32 v103, v247, v167
  buffer_store_dword v102, v48, s[76:79], s28 offen offset:0 sc1
  v_fmac_f32 v104, v248, v168
  buffer_store_dword v103, v48, s[76:79], s28 offen offset:1792 sc1
  v_fmac_f32 v105, v249, v169
  buffer_store_dword v104, v48, s[76:79], s28 offen offset:3584 sc1
  v_fmac_f32 v106, v250, v170
  buffer_store_dword v105, v48, s[76:79], s29 offen offset:0 sc1
  v_fmac_f32 v107, v251, v171
  buffer_store_dword v106, v48, s[76:79], s29 offen offset:1792 sc1
  v_fmac_f32 v108, v252, v172
  buffer_store_dword v107, v48, s[76:79], s29 offen offset:3584 sc1
  v_fmac_f32 v109, v253, v173
  buffer_store_dword v108, v48, s[76:79], s30 offen offset:0 sc1
  v_fmac_f32 v110, v254, v174
  buffer_store_dword v109, v48, s[76:79], s30 offen offset:1792 sc1
  v_fmac_f32 v111, v255, v175
  buffer_store_dword v110, v48, s[76:79], s30 offen offset:3584 sc1
  buffer_store_dword v111, v48, s[76:79], s31 offen offset:0 sc1
  s_endpgm
L_slow1:
  s_cmp_eq_u32 s3, 0
  s_cbranch_scc1 L_ok1
  s_sub_u32 s3, s3, 1
  global_load_dword v230, v231, s[16:17] sc1
  s_waitcnt vmcnt(0)
  s_branch L_chk1
L_slow2:
  s_cmp_eq_u32 s88, 0
  s_cbranch_scc1 L_ok2
  s_sub_u32 s88, s88, 1
  buffer_load_dwordx4 v[72:75], v31, s[68:71], s89 offen offset:0 sc1
  buffer_load_dwordx4 v[76:79], v31, s[68:71], s89 offen offset:512 sc1
  buffer_load_dwordx4 v[88:91], v31, s[68:71], s89 offen offset:1024 sc1
  buffer_load_dwordx4 v[92:95], v31, s[68:71], s89 offen offset:1536 sc1
  buffer_load_dwordx4 v[80:83], v31, s[68:71], s14 offen sc1
  buffer_load_dwordx4 v[84:87], v31, s[68:71], s15 offen sc1
  s_lshr_b32 s87, s82, 1
  s_lshl_b32 s87, s87, 9
  s_add_u32 s87, s87, s89
  buffer_load_dwordx4 a[252:255], v31, s[68:71], s87 offen offset:2048 sc1
  s_waitcnt vmcnt(0)
  s_branch L_chk2
L_slow3:
  s_cmp_eq_u32 s88, 0
  s_cbranch_scc1 L_ok3
  s_sub_u32 s88, s88, 1
  buffer_load_dwordx4 v[224:227], v51, s[72:75], 0 offen offset:0 sc1
  buffer_load_dwordx4 v[228:231], v51, s[72:75], 0 offen offset:1024 sc1
  buffer_load_dwordx4 v[232:235], v51, s[72:75], 0 offen offset:2048 sc1
  buffer_load_dwordx4 v[236:239], v51, s[72:75], 0 offen offset:3072 sc1
  s_mov_b32 s87, 4096
  buffer_load_dwordx4 v[240:243], v51, s[72:75], s87 offen offset:0 sc1
  buffer_load_dwordx4 v[244:247], v51, s[72:75], s87 offen offset:1024 sc1
  buffer_load_dwordx4 v[248:251], v51, s[72:75], s87 offen offset:2048 sc1
  buffer_load_dwordx4 v[252:255], v51, s[72:75], s87 offen offset:3072 sc1
  s_waitcnt vmcnt(0)
  s_branch L_chk3
L_slow4:
  s_cmp_eq_u32 s88, 0
  s_cbranch_scc1 L_ok4
  s_sub_u32 s88, s88, 1
  buffer_load_dword v52, off, s[68:71], s17 offset:896 sc1
  s_waitcnt vmcnt(0)
  s_branch L_chk4
L_slow5:
  s_cmp_eq_u32 s88, 0
  s_cbranch_scc1 L_ok5
  s_sub_u32 s88, s88, 1
  buffer_load_dwordx4 v[192:195], v43, s[76:79], s20 offen sc1
  buffer_load_dwordx4 v[196:199], v50, s[76:79], s20 offen sc1
  buffer_load_dwordx4 v[200:203], v43, s[76:79], s21 offen sc1
  buffer_load_dwordx4 v[204:207], v50, s[76:79], s21 offen sc1
  s_waitcnt vmcnt(0)
  s_branch L_chk5
L_slow6:
  s_cmp_eq_u32 s88, 0
  s_cbranch_scc1 L_ok6
  s_sub_u32 s88, s88, 1
  buffer_load_dwordx4 v[208:211], v43, s[76:79], s22 offen sc1
  buffer_load_dwordx4 v[212:215], v50, s[76:79], s22 offen sc1
  buffer_load_dwordx4 v[216:219], v43, s[76:79], s23 offen sc1
  buffer_load_dwordx4 v[220:223], v50, s[76:79], s23 offen sc1
  s_waitcnt vmcnt(0)
  s_branch L_chk6
L_slow7:
  s_cmp_eq_u32 s88, 0
  s_cbranch_scc1 L_ok7
  s_sub_u32 s88, s88, 1
  buffer_load_dwordx4 v[224:227], v43, s[76:79], s24 offen sc1
  buffer_load_dwordx4 v[228:231], v50, s[76:79], s24 offen sc1
  buffer_load_dwordx4 v[232:235], v43, s[76:79], s25 offen sc1
  buffer_load_dwordx4 v[236:239], v50, s[76:79], s25 offen sc1
  s_waitcnt vmcnt(0)
  s_branch L_chk7
L_slow8:
  s_cmp_eq_u32 s88, 0
  s_cbranch_scc1 L_ok8
  s_sub_u32 s88, s88, 1
  global_load_dword v79, v70, s[72:73] sc1
  s_waitcnt vmcnt(0)
  s_branch L_chk8
L_slow9:
  s_cmp_eq_u32 s88, 0
  s_cbranch_scc1 L_ok9
  s_sub_u32 s88, s88, 1
  buffer_load_dword v24, v72, s[68:71], s90 offen offset:12 sc1
  s_waitcnt vmcnt(0)
  s_branch L_chk9
L_slow10:
  s_cmp_eq_u32 s88, 0
  s_cbranch_scc1 L_ok10
  s_sub_u32 s88, s88, 1
  buffer_load_dwordx4 v[192:195], v43, s[76:79], s20 offen sc1
  buffer_load_dwordx4 v[196:199], v50, s[76:79], s20 offen sc1
  buffer_load_dwordx4 v[200:203], v43, s[76:79], s21 offen sc1
  buffer_load_dwordx4 v[204:207], v50, s[76:79], s21 offen sc1
  s_waitcnt vmcnt(0)
  s_branch L_chk10
L_slow11:
  s_cmp_eq_u32 s88, 0
  s_cbranch_scc1 L_ok11
  s_sub_u32 s88, s88, 1
  buffer_load_dwordx4 v[208:211], v43, s[76:79], s22 offen sc1
  buffer_load_dwordx4 v[212:215], v50, s[76:79], s22 offen sc1
  buffer_load_dwordx4 v[216:219], v43, s[76:79], s23 offen sc1
  buffer_load_dwordx4 v[220:223], v50, s[76:79], s23 offen sc1
  s_waitcnt vmcnt(0)
  s_branch L_chk11
L_slow12:
  s_cmp_eq_u32 s88, 0
  s_cbranch_scc1 L_ok12
  s_sub_u32 s88, s88, 1
  buffer_load_dwordx4 v[224:227], v43, s[76:79], s24 offen sc1
  buffer_load_dwordx4 v[228:231], v50, s[76:79], s24 offen sc1
  buffer_load_dwordx4 v[232:235], v43, s[76:79], s25 offen sc1
  buffer_load_dwordx4 v[236:239], v50, s[76:79], s25 offen sc1
  s_waitcnt vmcnt(0)
  s_branch L_chk12
L_end:
  s_endpgm
L_code_end:
.section .rodata,"a"
.p2align 6
.amdhsa_kernel gated_mix__ssm_conv_s5__mixer_channel_mlp__prompt_kernel
  .amdhsa_next_free_vgpr 512
  .amdhsa_next_free_sgpr 102
  .amdhsa_accum_offset 256
  .amdhsa_group_segment_fixed_size 0
  .amdhsa_kernarg_size 144
  .amdhsa_user_sgpr_count 2
  .amdhsa_user_sgpr_kernarg_segment_ptr 1
  .amdhsa_system_sgpr_workgroup_id_x 1
.end_amdhsa_kernel
```
